```python
import torch

def _softmax(x, axis=-1):
    return torch.softmax(x, dim=axis)
def _gelu(x):
    return torch.nn.functional.gelu(x, approximate="tanh")
def _silu(x):
    return torch.nn.functional.silu(x)
def _sigmoid(x):
    return torch.sigmoid(x)
def _layernorm(x, axis=-1, eps=1e-5):
    m = x.mean(dim=axis, keepdim=True)
    v = x.var(dim=axis, keepdim=True, unbiased=False)
    return (x - m) / torch.sqrt(v + eps)
def _scatter_add(tgt, idx, src, axis=0):
    return tgt.clone().index_add_(axis, idx, src)
def _segment_sum(src, seg, n):
    out = torch.zeros((n,) + src.shape[1:], dtype=src.dtype)
    return out.index_add_(0, seg, src)
def _pad(x, pw):
    flat = tuple(v for pair in reversed(pw) for v in pair)
    return torch.nn.functional.pad(x, flat)

kernel_name = 'parallel_sum__ssm_conv_h3__moe_arch_mod__prompt'

def setup_inputs():

    _w = (lambda a: (lambda t: t.to(torch.bfloat16) if t.is_floating_point() else t)(torch.as_tensor(a)))
    def _A_setup():
        B, S, D = 1, 2048, 1024
        ks = 4
        return {
            "q": _w((lambda *s: torch.randn(*s, dtype=torch.bfloat16) * 0.05)(B, S, D)),
            "k": _w((lambda *s: torch.randn(*s, dtype=torch.bfloat16) * 0.8)(B, S, D)),
            "v": _w((lambda *s: torch.randn(*s, dtype=torch.bfloat16) * 0.8)(B, S, D)),
            "shift_k": _w((lambda *s: torch.randn(*s, dtype=torch.bfloat16) * 0.8)(D, ks) * 0.5),
            "ssm_k": _w((lambda *s: torch.randn(*s, dtype=torch.bfloat16) * 0.8)(D, S) * (1.0 / S ** 0.5)),
            "ssm_D": _w((lambda *s: torch.randn(*s, dtype=torch.bfloat16) * 0.8)(D)),
        }
    _A_in = _A_setup()

    def _B_setup():
        B, S, D, F, C = 1, 2048, 1024, 3584, 2
        return {
            "x": _w((lambda *s: torch.randn(*s, dtype=torch.bfloat16) * 0.05)(B, S, D)),
            "w_r": _w((lambda *s: torch.randn(*s, dtype=torch.bfloat16) * 0.05)(D)),
            "w_gate": _w((lambda *s: torch.randn(*s, dtype=torch.bfloat16) * 0.05)(D, F)),
            "w_up": _w((lambda *s: torch.randn(*s, dtype=torch.bfloat16) * 0.05)(D, F)),
            "w_down": _w((lambda *s: torch.randn(*s, dtype=torch.bfloat16) * 0.05)(F, D)),
        }
    _B_in = _B_setup()

    return {
        "A_q": _A_in["q"],
        "A_k": _A_in["k"],
        "A_v": _A_in["v"],
        "A_shift_k": _A_in["shift_k"],
        "A_ssm_k": _A_in["ssm_k"],
        "A_ssm_D": _A_in["ssm_D"],
        "B_x": _B_in["x"],
        "B_w_r": _B_in["w_r"],
        "B_w_gate": _B_in["w_gate"],
        "B_w_up": _B_in["w_up"],
        "B_w_down": _B_in["w_down"],
    }

def reference(A_q, A_k, A_v, A_shift_k, A_ssm_k, A_ssm_D, B_x, B_w_r, B_w_gate, B_w_up, B_w_down):
    def _A_ref(q, k, v, shift_k, ssm_k, ssm_D):
        B, S, D = q.shape
        ks = shift_k.shape[-1]
        k_pad = _pad(k, ((0, 0), (ks - 1, 0), (0, 0)))
        k_shift = torch.zeros_like(k)
        for t in range(ks):
            k_shift = k_shift + k_pad[:, t:t + S, :] * shift_k[:, ks - 1 - t][None, None, :]
        kv = k_shift * v
        L = 2 * S
        kv_pad = _pad(kv, ((0, 0), (0, S), (0, 0)))
        kf_pad = _pad(ssm_k, ((0, 0), (0, S)))
        kv_f = (lambda x, axes=(-2,-1): torch.fft.rfft2(x.float(), dim=axes))(kv_pad[:, None, :, :], axes=(1, 2))
        kf_f = (lambda x, axes=(-2,-1): torch.fft.rfft2(x.float(), dim=axes))(kf_pad[:, None, :], axes=(1, 2))
        kf_f = (lambda x, *d: x.permute(*d))(kf_f, 1, 2, 0)
        y_f = kv_f * kf_f[None, :, :, :]
        y = (lambda x, s, axes=(-2,-1): torch.fft.irfft2(x, s=s, dim=axes).to(torch.bfloat16))(y_f, (1, L), axes=(1, 2))[:, 0, :S, :]
        y = y + kv * ssm_D[None, None, :]
        return q * y

    def _B_ref(x, w_r, w_gate, w_up, w_down):
        B, S, D = x.shape
        C = 2
        r = x @ w_r
        idx = torch.argsort(-r, axis=-1)[:, :C]
        idx_e = (lambda x, n, axis: torch.repeat_interleave(x, n, dim=axis))(idx.reshape(B, C, 1), D, axis=2)
        x_sel = (lambda x, i, axis: torch.take_along_dim(x, i, dim=axis))(x, idx_e, axis=1)
        g = _silu(x_sel @ w_gate)
        u = x_sel @ w_up
        y = (g * u) @ w_down
        r_sel = _sigmoid((lambda x, i, axis: torch.take_along_dim(x, i, dim=axis))(r, idx, axis=1))
        y = y * r_sel.reshape(B, C, 1)
        b_off = (torch.arange(B) * S).reshape(B, 1)
        flat_idx = (idx + b_off).reshape(B * C)
        zero = (x * 0.0).reshape(B * S, D)
        upd = _scatter_add(zero, flat_idx, y.reshape(B * C, D), axis=0)
        return x + upd.reshape(B, S, D)

    x = A_q
    xn = _layernorm(x, axis=-1)
    return x + _A_ref(xn, A_k, A_v, A_shift_k, A_ssm_k, A_ssm_D) + _B_ref(xn, B_w_r, B_w_gate, B_w_up, B_w_down)
```

```asm
; @launch grid=(256,1,1) block=(512,1,1) lds=121344
.amdgcn_target "amdgcn-amd-amdhsa--gfx950"
.text
.globl parallel_sum__ssm_conv_h3__moe_arch_mod__prompt_kernel
.p2align 8
.type parallel_sum__ssm_conv_h3__moe_arch_mod__prompt_kernel,@function
parallel_sum__ssm_conv_h3__moe_arch_mod__prompt_kernel:
    s_cmp_ge_u32 s2, 256
    s_cbranch_scc1 L_end
    s_load_dwordx16 s[16:31], s[0:1], 0
    s_load_dwordx8 s[32:39], s[0:1], 64
    s_load_dwordx4 s[40:43], s[0:1], 96
    v_lshrrev_b32 v3, 6, v0
    v_lshlrev_b32 v4, 3, v0
    v_and_b32 v0, 63, v0
    v_readfirstlane_b32 s15, v3
    v_mov_b32 v1, 0
    v_mov_b32 v6, 0
    v_mov_b32 v7, 0
    v_min_u32 v4, 248, v4
    ds_write_b64 v4, v[6:7]
    s_cmp_ge_u32 s2, 32
    s_cbranch_scc1 L_nocpf
    s_cmp_ge_u32 s15, 2
    s_cbranch_scc1 L_nocpf
    s_getpc_b64 s[8:9]
L_pc:
    s_lshl_b32 s7, s15, 13
    v_lshlrev_b32 v252, 7, v0
    v_add_u32 v252, s7, v252
    v_min_u32 v252, L_code_end-L_pc-4, v252
    v_mov_b32 v253, s9
    v_add_co_u32 v252, vcc, s8, v252
    s_nop 1
    v_addc_co_u32 v253, vcc, 0, v253, vcc
    global_load_dword v251, v[252:253], off
L_nocpf:
    s_and_b32 s4, s2, 7
    s_lshr_b32 s5, s2, 3
    s_and_b32 s3, s15, 3
    s_and_b32 s90, s3, 1
    s_lshr_b32 s91, s3, 1
    s_lshl_b32 s6, s5, 17
    s_lshl_b32 s7, s91, 16
    s_add_u32 s6, s6, s7
    s_lshl_b32 s7, s4, 8
    s_add_u32 s6, s6, s7
    s_lshl_b32 s7, s90, 7
    s_add_u32 s6, s6, s7
    v_and_b32 v9, 15, v0
    v_lshrrev_b32 v10, 4, v0
    v_lshlrev_b32 v2, 14, v10
    v_lshl_add_u32 v2, v9, 3, v2
    v_add_u32 v2, s6, v2
    v_mov_b32 v13, 1
    s_mov_b32 s84, 4096
    s_mov_b32 s85, 8192
    s_mov_b32 s86, 12288
    s_lshl_b32 s8, s2, 14
    s_lshl_b32 s7, s3, 12
    s_add_u32 s8, s8, s7
    v_lshlrev_b32 v3, 4, v0
    v_subrev_u32 v11, 6144, v2
    v_subrev_u32 v12, 2048, v2
    s_waitcnt lgkmcnt(0)
    s_barrier
    s_cmp_ge_u32 s15, 4
    s_cbranch_scc1 L_C
    s_mov_b32 s44, s16
    s_and_b32 s45, s17, 0xffff
    s_mov_b32 s46, 4194304
    s_mov_b32 s47, 0x20000
    buffer_load_dwordx4 v[16:19], v3, s[44:47], s8 offen
    buffer_load_dwordx4 v[20:23], v3, s[44:47], s8 offen offset:1024
    buffer_load_dwordx4 v[24:27], v3, s[44:47], s8 offen offset:2048
    buffer_load_dwordx4 v[28:31], v3, s[44:47], s8 offen offset:3072
    s_mov_b32 s64, s40
    s_and_b32 s65, s41, 0xffff
    s_mov_b32 s66, 256
    s_mov_b32 s67, 0x20000
    s_add_u32 s7, s2, s3
    s_cmp_eq_u32 s7, 0
    s_cbranch_scc0 L_m_nononce
    s_memrealtime s[8:9]
    s_waitcnt lgkmcnt(0)
    s_and_b32 s8, s8, -16
    v_mov_b32 v14, s8
    v_mov_b32 v15, s9
    s_mov_b64 exec, 1
    buffer_store_dwordx2 v[14:15], v1, s[64:67], 0 offen sc1
    s_mov_b64 exec, -1
L_m_nononce:
    s_mov_b32 s48, s30
    s_and_b32 s49, s31, 0xffff
    s_mov_b32 s50, 2048
    s_mov_b32 s51, 0x20000
    buffer_load_dwordx4 v[32:35], v3, s[48:51], 0 offen
    buffer_load_dwordx4 v[36:39], v3, s[48:51], 0 offen offset:1024
    s_branch L_M2
L_C:
    s_mov_b32 s44, s18
    s_and_b32 s45, s19, 0xffff
    s_mov_b32 s46, 4194304
    s_mov_b32 s47, 0x20000
    buffer_load_dwordx2 v[16:17], v11, s[44:47], 0 offen
    buffer_load_dwordx2 v[18:19], v11, s[44:47], 0 offen offset:2048
    buffer_load_dwordx2 v[20:21], v12, s[44:47], 0 offen
    buffer_load_dwordx2 v[22:23], v2, s[44:47], 0 offen
    buffer_load_dwordx2 v[24:25], v2, s[44:47], 0 offen offset:2048
    buffer_load_dwordx2 v[26:27], v2, s[44:47], s84 offen
    buffer_load_dwordx2 v[28:29], v2, s[44:47], s84 offen offset:2048
    buffer_load_dwordx2 v[30:31], v2, s[44:47], s85 offen
    buffer_load_dwordx2 v[32:33], v2, s[44:47], s85 offen offset:2048
    buffer_load_dwordx2 v[34:35], v2, s[44:47], s86 offen
    buffer_load_dwordx2 v[36:37], v2, s[44:47], s86 offen offset:2048
    s_mov_b32 s52, s22
    s_and_b32 s53, s23, 0xffff
    s_mov_b32 s54, 8192
    s_mov_b32 s55, 0x20000
    s_lshl_b32 s7, s4, 10
    s_lshl_b32 s8, s90, 9
    s_add_u32 s7, s7, s8
    v_lshlrev_b32 v11, 5, v9
    buffer_load_dwordx4 v[56:59], v11, s[52:55], s7 offen
    buffer_load_dwordx4 v[60:63], v11, s[52:55], s7 offen offset:16
    s_mov_b32 s48, s20
    s_and_b32 s49, s21, 0xffff
    s_mov_b32 s50, 4194304
    s_mov_b32 s51, 0x20000
    buffer_load_dwordx2 v[38:39], v2, s[48:51], 0 offen
    buffer_load_dwordx2 v[40:41], v2, s[48:51], 0 offen offset:2048
    buffer_load_dwordx2 v[42:43], v2, s[48:51], s84 offen
    buffer_load_dwordx2 v[44:45], v2, s[48:51], s84 offen offset:2048
    buffer_load_dwordx2 v[46:47], v2, s[48:51], s85 offen
    buffer_load_dwordx2 v[48:49], v2, s[48:51], s85 offen offset:2048
    buffer_load_dwordx2 v[50:51], v2, s[48:51], s86 offen
    buffer_load_dwordx2 v[52:53], v2, s[48:51], s86 offen offset:2048
    s_mov_b32 s64, s38
    s_and_b32 s65, s39, 0xffff
    s_mov_b32 s66, 4194304
    s_mov_b32 s67, 0x20000
    v_lshlrev_b32 v91, 4, v0
    v_lshlrev_b32 v3, 12, v9
    v_lshl_add_u32 v3, v10, 4, v3
    v_add_u32 v3, s6, v3
    v_lshl_add_u32 v11, v10, 4, v3
    buffer_load_dword v244, v11, s[64:67], 0 offen
    buffer_load_dword v245, v11, s[64:67], 0 offen offset:2048
    s_mov_b32 s56, s24
    s_and_b32 s57, s25, 0xffff
    s_mov_b32 s58, 4194304
    s_mov_b32 s59, 0x20000
    s_mov_b32 s60, s26
    s_and_b32 s61, s27, 0xffff
    s_mov_b32 s62, 2048
    s_mov_b32 s63, 0x20000
    s_lshl_b32 s95, s4, 7
    s_lshl_b32 s7, s5, 2
    s_add_u32 s95, s95, s7
    s_add_u32 s95, s95, s3
    s_mov_b32 s68, s42
    s_and_b32 s69, s43, 0xffff
    s_mov_b32 s70, 268435456
    s_mov_b32 s71, 0x20000
    s_mov_b32 s72, s40
    s_and_b32 s73, s41, 0xffff
    s_mov_b32 s74, 256
    s_mov_b32 s75, 0x20000
    s_mov_b32 s76, s38
    s_and_b32 s77, s39, 0xffff
    s_mov_b32 s78, 4194304
    s_mov_b32 s79, 0x20000
    s_mov_b32 s87, 0x100000
    s_mov_b32 s88, 0x200000
    s_mov_b32 s89, 0x300000
    s_getreg_b32 s92, hwreg(HW_REG_XCC_ID, 0, 4)
    s_lshr_b32 s97, s5, 4
    s_and_b32 s7, s5, 15
    s_lshl_b32 s7, s7, 2
    s_add_u32 s96, s7, s3
    s_lshr_b32 s9, s96, 1
    s_lshl_b32 s9, s9, 11
    s_lshl_b32 s7, s4, 8
    s_add_u32 s9, s9, s7
    s_lshl_b32 s7, s97, 7
    s_add_u32 s9, s9, s7
    s_and_b32 s7, s96, 1
    s_lshl_b32 s7, s7, 6
    s_add_u32 s9, s9, s7
    v_lshrrev_b32 v7, 2, v0
    v_lshlrev_b32 v7, 16, v7
    v_and_b32 v11, 3, v0
    v_lshl_add_u32 v7, v11, 4, v7
    v_add_u32 v7, s9, v7
    v_and_b32 v11, 1, v10
    v_lshlrev_b32 v11, 3, v11
    v_lshrrev_b32 v12, 1, v9
    v_add_u32 v11, v11, v12
    v_lshlrev_b32 v6, 16, v11
    v_and_b32 v11, 1, v9
    v_lshlrev_b32 v11, 1, v11
    v_lshrrev_b32 v12, 1, v10
    v_add_u32 v11, v11, v12
    v_lshl_add_u32 v6, v11, 4, v6
    v_add_u32 v6, s9, v6
    s_mul_i32 s10, s3, 16640
    s_add_u32 s10, s10, 54528
    s_mul_i32 s11, s3, 4608
    s_add_u32 s11, s11, 36096
    s_add_u32 s7, s11, 1008
    v_sub_u32 v8, s7, v91
    v_lshlrev_b32 v11, 5, v9
    s_add_u32 s7, s11, 480
    v_sub_u32 v5, s7, v11
    v_lshl_add_u32 v5, v10, 4, v5
    v_add_u32 v11, 1, v9
    v_and_b32 v12, 3, v11
    v_mul_u32_u24 v4, 4160, v12
    v_and_b32 v11, 0x1c, v11
    v_lshl_add_u32 v4, v11, 1, v4
    v_lshl_add_u32 v4, v10, 4, v4
    v_add_u32 v4, s10, v4
    s_lshl_b32 s7, s4, 1
    s_add_u32 s8, s7, s90
    s_lshl_b32 s8, s8, 6
    s_lshl_b32 s14, s5, 1
    s_add_u32 s8, s8, s14
    s_add_u32 s8, s8, s91
    s_lshl_b32 s8, s8, 3
    v_mov_b32 v90, s8
    s_add_u32 s8, s7, s97
    s_lshl_b32 s8, s8, 9
    v_lshlrev_b32 v89, 3, v0
    v_add_u32 v89, s8, v89
    v_mov_b32 v172, 0
    v_mov_b32 v173, 0
    v_mov_b32 v174, 0
    v_mov_b32 v175, 0
    v_lshlrev_b32 v11, 3, v0
    v_add_u32 v11, s11, v11
    ds_write_b64 v11, v[172:173] offset:4096
    v_bfe_u32 v11, v0, 1, 2
    v_mul_u32_u24 v11, 4160, v11
    v_and_b32 v12, 1, v0
    v_lshl_add_u32 v11, v12, 4, v11
    v_add_u32 v11, s10, v11
    ds_write_b128 v11, v[172:175]
    v_add_u32 v95, s10, v91
    s_mov_b32 s7, 32768
    s_mov_b32 s8, 40960
    s_mov_b32 s94, 1
    s_mov_b32 s98, 0
    s_setprio 1
    s_waitcnt vmcnt(10)
    buffer_load_dwordx2 v[14:15], v1, s[72:75], 0 offen sc1
    v_lshlrev_b32 v96, 16, v56
    v_and_b32 v100, 0xffff0000, v56
    v_lshlrev_b32 v104, 16, v57
    v_and_b32 v108, 0xffff0000, v57
    v_lshlrev_b32 v97, 16, v58
    v_and_b32 v101, 0xffff0000, v58
    v_lshlrev_b32 v105, 16, v59
    v_and_b32 v109, 0xffff0000, v59
    v_lshlrev_b32 v98, 16, v60
    v_and_b32 v102, 0xffff0000, v60
    v_lshlrev_b32 v106, 16, v61
    v_and_b32 v110, 0xffff0000, v61
    v_lshlrev_b32 v99, 16, v62
    v_and_b32 v103, 0xffff0000, v62
    v_lshlrev_b32 v107, 16, v63
    v_and_b32 v111, 0xffff0000, v63
    v_lshlrev_b32 v112, 16, v16
    v_and_b32 v113, 0xffff0000, v16
    v_lshlrev_b32 v114, 16, v17
    v_and_b32 v115, 0xffff0000, v17
    v_lshlrev_b32 v116, 16, v18
    v_and_b32 v117, 0xffff0000, v18
    v_lshlrev_b32 v118, 16, v19
    v_and_b32 v119, 0xffff0000, v19
    v_lshlrev_b32 v120, 16, v20
    v_and_b32 v121, 0xffff0000, v20
    v_lshlrev_b32 v122, 16, v21
    v_and_b32 v123, 0xffff0000, v21
    v_lshlrev_b32 v124, 16, v22
    v_and_b32 v125, 0xffff0000, v22
    v_lshlrev_b32 v126, 16, v23
    v_and_b32 v127, 0xffff0000, v23
    v_lshlrev_b32 v128, 16, v24
    v_and_b32 v129, 0xffff0000, v24
    v_lshlrev_b32 v130, 16, v25
    v_and_b32 v131, 0xffff0000, v25
    v_lshlrev_b32 v132, 16, v26
    v_and_b32 v133, 0xffff0000, v26
    v_lshlrev_b32 v134, 16, v27
    v_and_b32 v135, 0xffff0000, v27
    v_lshlrev_b32 v136, 16, v28
    v_and_b32 v137, 0xffff0000, v28
    v_lshlrev_b32 v138, 16, v29
    v_and_b32 v139, 0xffff0000, v29
    v_lshlrev_b32 v140, 16, v30
    v_and_b32 v141, 0xffff0000, v30
    v_lshlrev_b32 v142, 16, v31
    v_and_b32 v143, 0xffff0000, v31
    v_lshlrev_b32 v144, 16, v32
    v_and_b32 v145, 0xffff0000, v32
    v_lshlrev_b32 v146, 16, v33
    v_and_b32 v147, 0xffff0000, v33
    v_lshlrev_b32 v148, 16, v34
    v_and_b32 v149, 0xffff0000, v34
    v_lshlrev_b32 v150, 16, v35
    v_and_b32 v151, 0xffff0000, v35
    v_lshlrev_b32 v152, 16, v36
    v_and_b32 v153, 0xffff0000, v36
    v_lshlrev_b32 v154, 16, v37
    v_and_b32 v155, 0xffff0000, v37
    v_pk_mul_f32 v[172:173], v[112:113], v[108:109]
    v_pk_mul_f32 v[174:175], v[114:115], v[110:111]
    v_pk_fma_f32 v[172:173], v[116:117], v[104:105], v[172:173]
    v_pk_fma_f32 v[174:175], v[118:119], v[106:107], v[174:175]
    v_pk_fma_f32 v[172:173], v[120:121], v[100:101], v[172:173]
    v_pk_fma_f32 v[174:175], v[122:123], v[102:103], v[174:175]
    v_pk_fma_f32 v[172:173], v[124:125], v[96:97], v[172:173]
    v_pk_fma_f32 v[174:175], v[126:127], v[98:99], v[174:175]
    v_pk_mul_f32 v[176:177], v[116:117], v[108:109]
    v_pk_mul_f32 v[178:179], v[118:119], v[110:111]
    v_pk_fma_f32 v[176:177], v[120:121], v[104:105], v[176:177]
    v_pk_fma_f32 v[178:179], v[122:123], v[106:107], v[178:179]
    v_pk_fma_f32 v[176:177], v[124:125], v[100:101], v[176:177]
    v_pk_fma_f32 v[178:179], v[126:127], v[102:103], v[178:179]
    v_pk_fma_f32 v[176:177], v[128:129], v[96:97], v[176:177]
    v_pk_fma_f32 v[178:179], v[130:131], v[98:99], v[178:179]
    v_pk_mul_f32 v[180:181], v[120:121], v[108:109]
    v_pk_mul_f32 v[182:183], v[122:123], v[110:111]
    v_pk_fma_f32 v[180:181], v[124:125], v[104:105], v[180:181]
    v_pk_fma_f32 v[182:183], v[126:127], v[106:107], v[182:183]
    v_pk_fma_f32 v[180:181], v[128:129], v[100:101], v[180:181]
    v_pk_fma_f32 v[182:183], v[130:131], v[102:103], v[182:183]
    v_pk_fma_f32 v[180:181], v[132:133], v[96:97], v[180:181]
    v_pk_fma_f32 v[182:183], v[134:135], v[98:99], v[182:183]
    v_pk_mul_f32 v[184:185], v[124:125], v[108:109]
    v_pk_mul_f32 v[186:187], v[126:127], v[110:111]
    v_pk_fma_f32 v[184:185], v[128:129], v[104:105], v[184:185]
    v_pk_fma_f32 v[186:187], v[130:131], v[106:107], v[186:187]
    v_pk_fma_f32 v[184:185], v[132:133], v[100:101], v[184:185]
    v_pk_fma_f32 v[186:187], v[134:135], v[102:103], v[186:187]
    v_pk_fma_f32 v[184:185], v[136:137], v[96:97], v[184:185]
    v_pk_fma_f32 v[186:187], v[138:139], v[98:99], v[186:187]
    v_pk_mul_f32 v[188:189], v[128:129], v[108:109]
    v_pk_mul_f32 v[190:191], v[130:131], v[110:111]
    v_pk_fma_f32 v[188:189], v[132:133], v[104:105], v[188:189]
    v_pk_fma_f32 v[190:191], v[134:135], v[106:107], v[190:191]
    v_pk_fma_f32 v[188:189], v[136:137], v[100:101], v[188:189]
    v_pk_fma_f32 v[190:191], v[138:139], v[102:103], v[190:191]
    v_pk_fma_f32 v[188:189], v[140:141], v[96:97], v[188:189]
    v_pk_fma_f32 v[190:191], v[142:143], v[98:99], v[190:191]
    v_pk_mul_f32 v[192:193], v[132:133], v[108:109]
    v_pk_mul_f32 v[194:195], v[134:135], v[110:111]
    v_pk_fma_f32 v[192:193], v[136:137], v[104:105], v[192:193]
    v_pk_fma_f32 v[194:195], v[138:139], v[106:107], v[194:195]
    v_pk_fma_f32 v[192:193], v[140:141], v[100:101], v[192:193]
    v_pk_fma_f32 v[194:195], v[142:143], v[102:103], v[194:195]
    v_pk_fma_f32 v[192:193], v[144:145], v[96:97], v[192:193]
    v_pk_fma_f32 v[194:195], v[146:147], v[98:99], v[194:195]
    v_pk_mul_f32 v[196:197], v[136:137], v[108:109]
    v_pk_mul_f32 v[198:199], v[138:139], v[110:111]
    v_pk_fma_f32 v[196:197], v[140:141], v[104:105], v[196:197]
    v_pk_fma_f32 v[198:199], v[142:143], v[106:107], v[198:199]
    v_pk_fma_f32 v[196:197], v[144:145], v[100:101], v[196:197]
    v_pk_fma_f32 v[198:199], v[146:147], v[102:103], v[198:199]
    v_pk_fma_f32 v[196:197], v[148:149], v[96:97], v[196:197]
    v_pk_fma_f32 v[198:199], v[150:151], v[98:99], v[198:199]
    v_pk_mul_f32 v[200:201], v[140:141], v[108:109]
    v_pk_mul_f32 v[202:203], v[142:143], v[110:111]
    v_pk_fma_f32 v[200:201], v[144:145], v[104:105], v[200:201]
    v_pk_fma_f32 v[202:203], v[146:147], v[106:107], v[202:203]
    v_pk_fma_f32 v[200:201], v[148:149], v[100:101], v[200:201]
    v_pk_fma_f32 v[202:203], v[150:151], v[102:103], v[202:203]
    v_pk_fma_f32 v[200:201], v[152:153], v[96:97], v[200:201]
    v_pk_fma_f32 v[202:203], v[154:155], v[98:99], v[202:203]
    s_waitcnt vmcnt(3)
    v_lshlrev_b32 v112, 16, v38
    v_and_b32 v113, 0xffff0000, v38
    v_lshlrev_b32 v114, 16, v39
    v_and_b32 v115, 0xffff0000, v39
    v_lshlrev_b32 v116, 16, v40
    v_and_b32 v117, 0xffff0000, v40
    v_lshlrev_b32 v118, 16, v41
    v_and_b32 v119, 0xffff0000, v41
    v_lshlrev_b32 v120, 16, v42
    v_and_b32 v121, 0xffff0000, v42
    v_lshlrev_b32 v122, 16, v43
    v_and_b32 v123, 0xffff0000, v43
    v_lshlrev_b32 v124, 16, v44
    v_and_b32 v125, 0xffff0000, v44
    v_lshlrev_b32 v126, 16, v45
    v_and_b32 v127, 0xffff0000, v45
    v_lshlrev_b32 v128, 16, v46
    v_and_b32 v129, 0xffff0000, v46
    v_lshlrev_b32 v130, 16, v47
    v_and_b32 v131, 0xffff0000, v47
    v_lshlrev_b32 v132, 16, v48
    v_and_b32 v133, 0xffff0000, v48
    v_lshlrev_b32 v134, 16, v49
    v_and_b32 v135, 0xffff0000, v49
    v_lshlrev_b32 v136, 16, v50
    v_and_b32 v137, 0xffff0000, v50
    v_lshlrev_b32 v138, 16, v51
    v_and_b32 v139, 0xffff0000, v51
    v_lshlrev_b32 v140, 16, v52
    v_and_b32 v141, 0xffff0000, v52
    v_lshlrev_b32 v142, 16, v53
    v_and_b32 v143, 0xffff0000, v53
    v_pk_mul_f32 v[172:173], v[172:173], v[112:113]
    v_pk_mul_f32 v[174:175], v[174:175], v[114:115]
    v_pk_mul_f32 v[176:177], v[176:177], v[116:117]
    v_pk_mul_f32 v[178:179], v[178:179], v[118:119]
    v_pk_mul_f32 v[180:181], v[180:181], v[120:121]
    v_pk_mul_f32 v[182:183], v[182:183], v[122:123]
    v_pk_mul_f32 v[184:185], v[184:185], v[124:125]
    v_pk_mul_f32 v[186:187], v[186:187], v[126:127]
    v_pk_mul_f32 v[188:189], v[188:189], v[128:129]
    v_pk_mul_f32 v[190:191], v[190:191], v[130:131]
    v_pk_mul_f32 v[192:193], v[192:193], v[132:133]
    v_pk_mul_f32 v[194:195], v[194:195], v[134:135]
    v_pk_mul_f32 v[196:197], v[196:197], v[136:137]
    v_pk_mul_f32 v[198:199], v[198:199], v[138:139]
    v_pk_mul_f32 v[200:201], v[200:201], v[140:141]
    v_pk_mul_f32 v[202:203], v[202:203], v[142:143]
    v_cvt_pk_bf16_f32 v159, v176, v172
    v_cvt_pk_bf16_f32 v158, v184, v180
    v_cvt_pk_bf16_f32 v157, v192, v188
    v_cvt_pk_bf16_f32 v156, v200, v196
    buffer_store_dwordx4 v[156:159], v3, s[64:67], 0 offen
    v_cvt_pk_bf16_f32 v163, v177, v173
    v_cvt_pk_bf16_f32 v162, v185, v181
    v_cvt_pk_bf16_f32 v161, v193, v189
    v_cvt_pk_bf16_f32 v160, v201, v197
    buffer_store_dwordx4 v[160:163], v3, s[64:67], 0 offen offset:64
    v_cvt_pk_bf16_f32 v167, v178, v174
    v_cvt_pk_bf16_f32 v166, v186, v182
    v_cvt_pk_bf16_f32 v165, v194, v190
    v_cvt_pk_bf16_f32 v164, v202, v198
    buffer_store_dwordx4 v[164:167], v3, s[64:67], 0 offen offset:2048
    v_cvt_pk_bf16_f32 v171, v179, v175
    v_cvt_pk_bf16_f32 v170, v187, v183
    v_cvt_pk_bf16_f32 v169, v195, v191
    v_cvt_pk_bf16_f32 v168, v203, v199
    buffer_store_dwordx4 v[168:171], v3, s[64:67], 0 offen offset:2112
    s_mov_b64 exec, 1
    ds_add_u32 v1, v13 offset:24
    s_mov_b64 exec, -1
    s_mov_b32 s93, 0
L_lw9:
    ds_read_b32 v12, v1 offset:24
    s_waitcnt lgkmcnt(0)
    v_cmp_le_u32 vcc, 4, v12
    s_nop 3
    s_cbranch_vccnz L_lw9_ok
    s_add_u32 s93, s93, 1
    s_sleep 1
    s_cmp_lt_u32 s93, 480000
    s_cbranch_scc1 L_lw9
L_lw9_ok:
    s_lshl_b32 s12, s95, 12
    s_lshl_b32 s13, s95, 1
    buffer_load_ushort v88, v1, s[60:63], s13 offen
    buffer_load_dwordx4 v[64:67], v91, s[56:59], s12 offen
    buffer_load_dwordx2 v[68:69], v91, s[56:59], s12 offen offset:16
    buffer_load_dwordx4 v[70:73], v91, s[56:59], s12 offen offset:1024
    buffer_load_dwordx2 v[74:75], v91, s[56:59], s12 offen offset:1040
    buffer_load_dwordx4 v[76:79], v91, s[56:59], s12 offen offset:2048
    buffer_load_dwordx2 v[80:81], v91, s[56:59], s12 offen offset:2064
    buffer_load_dwordx4 v[82:85], v91, s[56:59], s12 offen offset:3072
    buffer_load_dwordx2 v[86:87], v91, s[56:59], s12 offen offset:3088
    s_mov_b64 exec, 1
    ds_add_u32 v1, v13 offset:20
    s_mov_b64 exec, -1
    s_waitcnt vmcnt(9)
    s_mov_b32 s93, 0
L_c_nonce:
    v_cmp_ne_u64 vcc, 0, v[14:15]
    s_nop 3
    s_cbranch_vccnz L_c_nonce_ok
    buffer_load_dwordx2 v[14:15], v1, s[72:75], 0 offen sc1
    s_add_u32 s93, s93, 1
    s_sleep 2
    s_waitcnt vmcnt(0)
    s_cmp_lt_u32 s93, 60000
    s_cbranch_scc1 L_c_nonce
L_c_nonce_ok:
    v_or_b32 v54, s92, v14
    v_mov_b32 v55, v15
    s_mov_b64 exec, 1
    buffer_store_dwordx2 v[54:55], v90, s[68:71], s7 offen
    s_mov_b64 exec, -1
    s_waitcnt vmcnt(7)
    v_lshlrev_b32 v11, 3, v10
    v_add_u32 v11, v11, v9
    v_sub_u32 v11, 15, v11
    v_and_b32 v12, 1, v11
    v_lshlrev_b32 v12, 4, v12
    v_lshlrev_b32 v12, v12, v88
    v_ashrrev_i32 v11, 1, v11
    v_cmp_eq_u32 vcc, 0, v11
    s_nop 1
    v_cndmask_b32 v216, 0, v12, vcc
    v_cmp_eq_u32 vcc, 1, v11
    s_nop 1
    v_cndmask_b32 v217, 0, v12, vcc
    v_cmp_eq_u32 vcc, 2, v11
    s_nop 1
    v_cndmask_b32 v218, 0, v12, vcc
    v_cmp_eq_u32 vcc, 3, v11
    s_nop 1
    v_cndmask_b32 v219, 0, v12, vcc
    ds_write_b128 v95, v[64:67] offset:32
    v_alignbyte_b32 v96, v65, v64, 2
    v_alignbyte_b32 v97, v66, v65, 2
    v_alignbyte_b32 v98, v67, v66, 2
    v_alignbyte_b32 v99, v68, v67, 2
    ds_write_b128 v95, v[96:99] offset:4192
    v_mov_b32 v100, v65
    v_mov_b32 v101, v66
    v_mov_b32 v102, v67
    v_mov_b32 v103, v68
    ds_write_b128 v95, v[100:103] offset:8352
    v_alignbyte_b32 v104, v66, v65, 2
    v_alignbyte_b32 v105, v67, v66, 2
    v_alignbyte_b32 v106, v68, v67, 2
    v_alignbyte_b32 v107, v69, v68, 2
    ds_write_b128 v95, v[104:107] offset:12512
    v_lshlrev_b32 v12, 16, v64
    s_mov_b64 exec, 1
    ds_write_b32 v95, v12 offset:4188
    ds_write_b32 v95, v64 offset:8348
    ds_write_b32 v95, v12 offset:12504
    ds_write_b32 v95, v96 offset:12508
    s_mov_b64 exec, -1
    s_waitcnt vmcnt(5)
    buffer_load_dwordx2 v[92:93], v89, s[68:71], s7 offen sc1
    ds_write_b128 v95, v[70:73] offset:1056
    v_alignbyte_b32 v108, v71, v70, 2
    v_alignbyte_b32 v109, v72, v71, 2
    v_alignbyte_b32 v110, v73, v72, 2
    v_alignbyte_b32 v111, v74, v73, 2
    ds_write_b128 v95, v[108:111] offset:5216
    v_mov_b32 v112, v71
    v_mov_b32 v113, v72
    v_mov_b32 v114, v73
    v_mov_b32 v115, v74
    ds_write_b128 v95, v[112:115] offset:9376
    v_alignbyte_b32 v116, v72, v71, 2
    v_alignbyte_b32 v117, v73, v72, 2
    v_alignbyte_b32 v118, v74, v73, 2
    v_alignbyte_b32 v119, v75, v74, 2
    ds_write_b128 v95, v[116:119] offset:13536
    s_waitcnt vmcnt(4)
    ds_write_b128 v95, v[76:79] offset:2080
    v_alignbyte_b32 v96, v77, v76, 2
    v_alignbyte_b32 v97, v78, v77, 2
    v_alignbyte_b32 v98, v79, v78, 2
    v_alignbyte_b32 v99, v80, v79, 2
    ds_write_b128 v95, v[96:99] offset:6240
    v_mov_b32 v100, v77
    v_mov_b32 v101, v78
    v_mov_b32 v102, v79
    v_mov_b32 v103, v80
    ds_write_b128 v95, v[100:103] offset:10400
    v_alignbyte_b32 v104, v78, v77, 2
    v_alignbyte_b32 v105, v79, v78, 2
    v_alignbyte_b32 v106, v80, v79, 2
    v_alignbyte_b32 v107, v81, v80, 2
    ds_write_b128 v95, v[104:107] offset:14560
    s_waitcnt vmcnt(1)
    s_cmp_eq_u32 s98, 1
    s_cbranch_scc1 L_c_ps2
    s_waitcnt vmcnt(0)
    v_cmp_eq_u64 vcc, v[92:93], v[54:55]
    s_nop 0
    s_cmp_eq_u64 vcc, exec
    s_nop 1
    s_cbranch_scc1 L_c_ps2_f
    buffer_load_dwordx2 v[92:93], v89, s[68:71], s7 offen sc1
    s_branch L_c_ps2
L_c_ps2_f:
    buffer_load_dwordx4 v[220:223], v7, s[76:79], 0 offen sc1
    buffer_load_dwordx4 v[224:227], v7, s[76:79], s87 offen sc1
    buffer_load_dwordx4 v[228:231], v7, s[76:79], s88 offen sc1
    buffer_load_dwordx4 v[232:235], v7, s[76:79], s89 offen sc1
    s_mov_b64 exec, 1
    ds_add_u32 v1, v13 offset:16
    s_mov_b64 exec, -1
    s_mov_b32 s98, 1
L_c_ps2:
    ds_write_b128 v95, v[82:85] offset:3104
    v_alignbyte_b32 v108, v83, v82, 2
    v_alignbyte_b32 v109, v84, v83, 2
    v_alignbyte_b32 v110, v85, v84, 2
    v_alignbyte_b32 v111, v86, v85, 2
    ds_write_b128 v95, v[108:111] offset:7264
    v_mov_b32 v112, v83
    v_mov_b32 v113, v84
    v_mov_b32 v114, v85
    v_mov_b32 v115, v86
    ds_write_b128 v95, v[112:115] offset:11424
    v_alignbyte_b32 v116, v84, v83, 2
    v_alignbyte_b32 v117, v85, v84, 2
    v_alignbyte_b32 v118, v86, v85, 2
    v_alignbyte_b32 v119, v87, v86, 2
    ds_write_b128 v95, v[116:119] offset:15584
    s_mov_b32 s93, 0
    s_cmp_eq_u32 s98, 1
    s_cbranch_scc1 L_c_fetched
L_c_poll:
    s_waitcnt vmcnt(0)
    v_cmp_eq_u64 vcc, v[92:93], v[54:55]
    s_nop 0
    s_cmp_eq_u64 vcc, exec
    s_nop 1
    s_cbranch_scc1 L_c_fetch
    buffer_load_dwordx2 v[92:93], v89, s[68:71], s7 offen sc1
    s_add_u32 s93, s93, 1
    s_cmp_lt_u32 s93, 40
    s_cbranch_scc1 L_c_poll
    s_branch L_c_slow
L_c_fetch:
    buffer_load_dwordx4 v[220:223], v7, s[76:79], 0 offen sc1
    buffer_load_dwordx4 v[224:227], v7, s[76:79], s87 offen sc1
    buffer_load_dwordx4 v[228:231], v7, s[76:79], s88 offen sc1
    buffer_load_dwordx4 v[232:235], v7, s[76:79], s89 offen sc1
    s_mov_b64 exec, 1
    ds_add_u32 v1, v13 offset:16
    s_mov_b64 exec, -1
L_c_fetched:
    s_add_u32 s12, s94, 1
    v_mov_b32 v12, s12
    ds_write_b32 v1, v12 offset:28
    ds_read_b64 v[156:157], v4 offset:3584
    ds_read_b64 v[158:159], v4 offset:3592
    ds_read_b64 v[152:153], v4 offset:3072
    ds_read_b64 v[154:155], v4 offset:3080
    ds_read_b64 v[148:149], v4 offset:2560
    ds_read_b64 v[150:151], v4 offset:2568
    ds_read_b64 v[144:145], v4 offset:2048
    ds_read_b64 v[146:147], v4 offset:2056
    ds_read_b64 v[140:141], v4 offset:1536
    ds_read_b64 v[142:143], v4 offset:1544
    ds_read_b64 v[136:137], v4 offset:1024
    ds_read_b64 v[138:139], v4 offset:1032
    ds_read_b64 v[132:133], v4 offset:512
    ds_read_b64 v[134:135], v4 offset:520
    ds_read_b64 v[128:129], v4 offset:0
    ds_read_b64 v[130:131], v4 offset:8
    s_waitcnt vmcnt(3)
    ds_write_b128 v8, v[220:223] offset:3072
    s_waitcnt vmcnt(2)
    ds_write_b128 v8, v[224:227] offset:2048
    s_waitcnt vmcnt(1)
    ds_write_b128 v8, v[228:231] offset:1024
    s_waitcnt vmcnt(0)
    ds_write_b128 v8, v[232:235] offset:0
    ds_read_b128 v[176:179], v5 offset:3584
    ds_read_b128 v[180:183], v5 offset:3072
    ds_read_b128 v[184:187], v5 offset:2560
    ds_read_b128 v[188:191], v5 offset:2048
    ds_read_b128 v[192:195], v5 offset:1536
    ds_read_b128 v[196:199], v5 offset:1024
    ds_read_b128 v[200:203], v5 offset:512
    ds_read_b128 v[204:207], v5 offset:0
    s_waitcnt lgkmcnt(7)
    v_mfma_f32_16x16x32_bf16 v[96:99], v[216:219], v[176:179], 0
    s_waitcnt lgkmcnt(6)
    v_mfma_f32_16x16x32_bf16 v[100:103], v[216:219], v[180:183], 0
    s_waitcnt lgkmcnt(5)
    v_mfma_f32_16x16x32_bf16 v[104:107], v[216:219], v[184:187], 0
    s_waitcnt lgkmcnt(4)
    v_mfma_f32_16x16x32_bf16 v[108:111], v[216:219], v[188:191], 0
    s_waitcnt lgkmcnt(3)
    v_mfma_f32_16x16x32_bf16 v[112:115], v[216:219], v[192:195], 0
    s_waitcnt lgkmcnt(2)
    v_mfma_f32_16x16x32_bf16 v[116:119], v[216:219], v[196:199], 0
    s_waitcnt lgkmcnt(1)
    v_mfma_f32_16x16x32_bf16 v[120:123], v[216:219], v[200:203], 0
    s_waitcnt lgkmcnt(0)
    v_mfma_f32_16x16x32_bf16 v[124:127], v[216:219], v[204:207], 0
    s_mov_b32 s93, 0
    s_lshl_b32 s7, s95, 3
    s_add_u32 s7, s7, 49152
    s_sub_u32 s8, 4, s94
L_conv:
    s_waitcnt lgkmcnt(14)
    v_mfma_f32_16x16x32_bf16 v[124:127], v[156:159], v[176:179], v[124:127]
    ds_read_b64 v[128:129], v4 offset:0
    v_mfma_f32_16x16x32_bf16 v[120:123], v[152:155], v[176:179], v[120:123]
    ds_read_b64 v[130:131], v4 offset:8
    s_waitcnt lgkmcnt(14)
    v_mfma_f32_16x16x32_bf16 v[124:127], v[152:155], v[180:183], v[124:127]
    ds_read_b64 v[156:157], v4 offset:3648
    v_mfma_f32_16x16x32_bf16 v[116:119], v[148:151], v[176:179], v[116:119]
    ds_read_b64 v[158:159], v4 offset:3656
    v_mfma_f32_16x16x32_bf16 v[120:123], v[148:151], v[180:183], v[120:123]
    ds_read_b64 v[152:153], v4 offset:3136
    s_waitcnt lgkmcnt(10)
    v_mfma_f32_16x16x32_bf16 v[124:127], v[148:151], v[184:187], v[124:127]
    ds_read_b64 v[154:155], v4 offset:3144
    v_mfma_f32_16x16x32_bf16 v[112:115], v[144:147], v[176:179], v[112:115]
    ds_read_b64 v[148:149], v4 offset:2624
    v_mfma_f32_16x16x32_bf16 v[116:119], v[144:147], v[180:183], v[116:119]
    ds_read_b64 v[150:151], v4 offset:2632
    v_mfma_f32_16x16x32_bf16 v[120:123], v[144:147], v[184:187], v[120:123]
    ds_read_b128 v[208:211], v5 offset:3648
    s_waitcnt lgkmcnt(13)
    v_mfma_f32_16x16x32_bf16 v[124:127], v[144:147], v[188:191], v[124:127]
    v_mfma_f32_16x16x32_bf16 v[108:111], v[140:143], v[176:179], v[108:111]
    ds_read_b64 v[144:145], v4 offset:2112
    v_mfma_f32_16x16x32_bf16 v[112:115], v[140:143], v[180:183], v[112:115]
    ds_read_b64 v[146:147], v4 offset:2120
    v_mfma_f32_16x16x32_bf16 v[116:119], v[140:143], v[184:187], v[116:119]
    ds_read_b128 v[212:215], v5 offset:3136
    v_mfma_f32_16x16x32_bf16 v[120:123], v[140:143], v[188:191], v[120:123]
    s_waitcnt lgkmcnt(14)
    v_mfma_f32_16x16x32_bf16 v[124:127], v[140:143], v[192:195], v[124:127]
    v_mfma_f32_16x16x32_bf16 v[104:107], v[136:139], v[176:179], v[104:107]
    ds_read_b64 v[140:141], v4 offset:1600
    v_mfma_f32_16x16x32_bf16 v[108:111], v[136:139], v[180:183], v[108:111]
    ds_read_b64 v[142:143], v4 offset:1608
    v_mfma_f32_16x16x32_bf16 v[112:115], v[136:139], v[184:187], v[112:115]
    v_mfma_f32_16x16x32_bf16 v[116:119], v[136:139], v[188:191], v[116:119]
    v_mfma_f32_16x16x32_bf16 v[120:123], v[136:139], v[192:195], v[120:123]
    v_mfma_f32_16x16x32_bf16 v[124:127], v[136:139], v[196:199], v[124:127]
    v_mfma_f32_16x16x32_bf16 v[100:103], v[132:135], v[176:179], v[100:103]
    ds_read_b64 v[136:137], v4 offset:1088
    v_mfma_f32_16x16x32_bf16 v[104:107], v[132:135], v[180:183], v[104:107]
    ds_read_b64 v[138:139], v4 offset:1096
    v_mfma_f32_16x16x32_bf16 v[108:111], v[132:135], v[184:187], v[108:111]
    v_mfma_f32_16x16x32_bf16 v[112:115], v[132:135], v[188:191], v[112:115]
    v_mfma_f32_16x16x32_bf16 v[116:119], v[132:135], v[192:195], v[116:119]
    v_mfma_f32_16x16x32_bf16 v[120:123], v[132:135], v[196:199], v[120:123]
    s_waitcnt lgkmcnt(14)
    v_mfma_f32_16x16x32_bf16 v[124:127], v[132:135], v[200:203], v[124:127]
    v_mfma_f32_16x16x32_bf16 v[96:99], v[128:131], v[176:179], v[96:99]
    ds_read_b64 v[132:133], v4 offset:576
    v_mfma_f32_16x16x32_bf16 v[100:103], v[128:131], v[180:183], v[100:103]
    ds_read_b64 v[134:135], v4 offset:584
    v_mfma_f32_16x16x32_bf16 v[104:107], v[128:131], v[184:187], v[104:107]
    ds_read_b128 v[184:187], v5 offset:2624
    v_mfma_f32_16x16x32_bf16 v[108:111], v[128:131], v[188:191], v[108:111]
    ds_read_b128 v[188:191], v5 offset:2112
    v_mfma_f32_16x16x32_bf16 v[112:115], v[128:131], v[192:195], v[112:115]
    ds_read_b128 v[192:195], v5 offset:1600
    v_mfma_f32_16x16x32_bf16 v[116:119], v[128:131], v[196:199], v[116:119]
    ds_read_b128 v[196:199], v5 offset:1088
    v_mfma_f32_16x16x32_bf16 v[120:123], v[128:131], v[200:203], v[120:123]
    ds_read_b128 v[200:203], v5 offset:576
    v_mfma_f32_16x16x32_bf16 v[124:127], v[128:131], v[204:207], v[124:127]
    ds_read_b128 v[204:207], v5 offset:64
    s_waitcnt lgkmcnt(14)
    v_mfma_f32_16x16x32_bf16 v[124:127], v[156:159], v[208:211], v[124:127]
    ds_read_b64 v[128:129], v4 offset:64
    v_mfma_f32_16x16x32_bf16 v[120:123], v[152:155], v[208:211], v[120:123]
    ds_read_b64 v[130:131], v4 offset:72
    s_waitcnt lgkmcnt(14)
    v_mfma_f32_16x16x32_bf16 v[124:127], v[152:155], v[212:215], v[124:127]
    ds_read_b64 v[156:157], v4 offset:3712
    v_mfma_f32_16x16x32_bf16 v[116:119], v[148:151], v[208:211], v[116:119]
    ds_read_b64 v[158:159], v4 offset:3720
    v_mfma_f32_16x16x32_bf16 v[120:123], v[148:151], v[212:215], v[120:123]
    ds_read_b64 v[152:153], v4 offset:3200
    s_waitcnt lgkmcnt(10)
    v_mfma_f32_16x16x32_bf16 v[124:127], v[148:151], v[184:187], v[124:127]
    ds_read_b64 v[154:155], v4 offset:3208
    v_mfma_f32_16x16x32_bf16 v[112:115], v[144:147], v[208:211], v[112:115]
    ds_read_b64 v[148:149], v4 offset:2688
    v_mfma_f32_16x16x32_bf16 v[116:119], v[144:147], v[212:215], v[116:119]
    ds_read_b64 v[150:151], v4 offset:2696
    v_mfma_f32_16x16x32_bf16 v[120:123], v[144:147], v[184:187], v[120:123]
    ds_read_b128 v[176:179], v5 offset:3712
    s_waitcnt lgkmcnt(13)
    v_mfma_f32_16x16x32_bf16 v[124:127], v[144:147], v[188:191], v[124:127]
    v_mfma_f32_16x16x32_bf16 v[108:111], v[140:143], v[208:211], v[108:111]
    ds_read_b64 v[144:145], v4 offset:2176
    v_mfma_f32_16x16x32_bf16 v[112:115], v[140:143], v[212:215], v[112:115]
    ds_read_b64 v[146:147], v4 offset:2184
    v_mfma_f32_16x16x32_bf16 v[116:119], v[140:143], v[184:187], v[116:119]
    ds_read_b128 v[180:183], v5 offset:3200
    v_mfma_f32_16x16x32_bf16 v[120:123], v[140:143], v[188:191], v[120:123]
    s_waitcnt lgkmcnt(14)
    v_mfma_f32_16x16x32_bf16 v[124:127], v[140:143], v[192:195], v[124:127]
    v_mfma_f32_16x16x32_bf16 v[104:107], v[136:139], v[208:211], v[104:107]
    ds_read_b64 v[140:141], v4 offset:1664
    v_mfma_f32_16x16x32_bf16 v[108:111], v[136:139], v[212:215], v[108:111]
    ds_read_b64 v[142:143], v4 offset:1672
    v_mfma_f32_16x16x32_bf16 v[112:115], v[136:139], v[184:187], v[112:115]
    v_mfma_f32_16x16x32_bf16 v[116:119], v[136:139], v[188:191], v[116:119]
    v_mfma_f32_16x16x32_bf16 v[120:123], v[136:139], v[192:195], v[120:123]
    v_mfma_f32_16x16x32_bf16 v[124:127], v[136:139], v[196:199], v[124:127]
    v_mfma_f32_16x16x32_bf16 v[100:103], v[132:135], v[208:211], v[100:103]
    ds_read_b64 v[136:137], v4 offset:1152
    v_mfma_f32_16x16x32_bf16 v[104:107], v[132:135], v[212:215], v[104:107]
    ds_read_b64 v[138:139], v4 offset:1160
    v_mfma_f32_16x16x32_bf16 v[108:111], v[132:135], v[184:187], v[108:111]
    v_mfma_f32_16x16x32_bf16 v[112:115], v[132:135], v[188:191], v[112:115]
    v_mfma_f32_16x16x32_bf16 v[116:119], v[132:135], v[192:195], v[116:119]
    v_mfma_f32_16x16x32_bf16 v[120:123], v[132:135], v[196:199], v[120:123]
    s_waitcnt lgkmcnt(14)
    v_mfma_f32_16x16x32_bf16 v[124:127], v[132:135], v[200:203], v[124:127]
    v_mfma_f32_16x16x32_bf16 v[96:99], v[128:131], v[208:211], v[96:99]
    ds_read_b64 v[132:133], v4 offset:640
    v_mfma_f32_16x16x32_bf16 v[100:103], v[128:131], v[212:215], v[100:103]
    ds_read_b64 v[134:135], v4 offset:648
    v_mfma_f32_16x16x32_bf16 v[104:107], v[128:131], v[184:187], v[104:107]
    ds_read_b128 v[184:187], v5 offset:2688
    v_mfma_f32_16x16x32_bf16 v[108:111], v[128:131], v[188:191], v[108:111]
    ds_read_b128 v[188:191], v5 offset:2176
    v_mfma_f32_16x16x32_bf16 v[112:115], v[128:131], v[192:195], v[112:115]
    ds_read_b128 v[192:195], v5 offset:1664
    v_mfma_f32_16x16x32_bf16 v[116:119], v[128:131], v[196:199], v[116:119]
    ds_read_b128 v[196:199], v5 offset:1152
    v_mfma_f32_16x16x32_bf16 v[120:123], v[128:131], v[200:203], v[120:123]
    ds_read_b128 v[200:203], v5 offset:640
    v_mfma_f32_16x16x32_bf16 v[124:127], v[128:131], v[204:207], v[124:127]
    ds_read_b128 v[204:207], v5 offset:128
    v_add_u32 v4, 128, v4
    v_add_u32 v5, 128, v5
    s_add_u32 s93, s93, 1
    s_cmp_lt_u32 s93, s8
    s_cbranch_scc1 L_conv
L_conv_end:
    s_cmp_eq_u32 s94, 1
    s_cbranch_scc0 L_c_ysl
    s_waitcnt lgkmcnt(14)
    v_mfma_f32_16x16x32_bf16 v[124:127], v[156:159], v[176:179], v[124:127]
    ds_read_b64 v[128:129], v4 offset:0
    v_mfma_f32_16x16x32_bf16 v[120:123], v[152:155], v[176:179], v[120:123]
    ds_read_b64 v[130:131], v4 offset:8
    s_waitcnt lgkmcnt(14)
    v_mfma_f32_16x16x32_bf16 v[124:127], v[152:155], v[180:183], v[124:127]
    ds_read_b64 v[156:157], v4 offset:3648
    v_mfma_f32_16x16x32_bf16 v[116:119], v[148:151], v[176:179], v[116:119]
    ds_read_b64 v[158:159], v4 offset:3656
    v_mfma_f32_16x16x32_bf16 v[120:123], v[148:151], v[180:183], v[120:123]
    ds_read_b64 v[152:153], v4 offset:3136
    s_waitcnt lgkmcnt(10)
    v_mfma_f32_16x16x32_bf16 v[124:127], v[148:151], v[184:187], v[124:127]
    ds_read_b64 v[154:155], v4 offset:3144
    v_mfma_f32_16x16x32_bf16 v[112:115], v[144:147], v[176:179], v[112:115]
    ds_read_b64 v[148:149], v4 offset:2624
    v_mfma_f32_16x16x32_bf16 v[116:119], v[144:147], v[180:183], v[116:119]
    ds_read_b64 v[150:151], v4 offset:2632
    v_mfma_f32_16x16x32_bf16 v[120:123], v[144:147], v[184:187], v[120:123]
    ds_read_b128 v[208:211], v5 offset:3648
    s_waitcnt lgkmcnt(13)
    v_mfma_f32_16x16x32_bf16 v[124:127], v[144:147], v[188:191], v[124:127]
    v_mfma_f32_16x16x32_bf16 v[108:111], v[140:143], v[176:179], v[108:111]
    ds_read_b64 v[144:145], v4 offset:2112
    v_mfma_f32_16x16x32_bf16 v[112:115], v[140:143], v[180:183], v[112:115]
    ds_read_b64 v[146:147], v4 offset:2120
    v_mfma_f32_16x16x32_bf16 v[116:119], v[140:143], v[184:187], v[116:119]
    ds_read_b128 v[212:215], v5 offset:3136
    v_mfma_f32_16x16x32_bf16 v[120:123], v[140:143], v[188:191], v[120:123]
    s_waitcnt lgkmcnt(14)
    v_mfma_f32_16x16x32_bf16 v[124:127], v[140:143], v[192:195], v[124:127]
    v_mfma_f32_16x16x32_bf16 v[104:107], v[136:139], v[176:179], v[104:107]
    ds_read_b64 v[140:141], v4 offset:1600
    v_mfma_f32_16x16x32_bf16 v[108:111], v[136:139], v[180:183], v[108:111]
    ds_read_b64 v[142:143], v4 offset:1608
    v_mfma_f32_16x16x32_bf16 v[112:115], v[136:139], v[184:187], v[112:115]
    v_mfma_f32_16x16x32_bf16 v[116:119], v[136:139], v[188:191], v[116:119]
    v_mfma_f32_16x16x32_bf16 v[120:123], v[136:139], v[192:195], v[120:123]
    v_mfma_f32_16x16x32_bf16 v[124:127], v[136:139], v[196:199], v[124:127]
    v_mfma_f32_16x16x32_bf16 v[100:103], v[132:135], v[176:179], v[100:103]
    ds_read_b64 v[136:137], v4 offset:1088
    v_mfma_f32_16x16x32_bf16 v[104:107], v[132:135], v[180:183], v[104:107]
    ds_read_b64 v[138:139], v4 offset:1096
    v_mfma_f32_16x16x32_bf16 v[108:111], v[132:135], v[184:187], v[108:111]
    v_mfma_f32_16x16x32_bf16 v[112:115], v[132:135], v[188:191], v[112:115]
    v_mfma_f32_16x16x32_bf16 v[116:119], v[132:135], v[192:195], v[116:119]
    v_mfma_f32_16x16x32_bf16 v[120:123], v[132:135], v[196:199], v[120:123]
    s_waitcnt lgkmcnt(14)
    v_mfma_f32_16x16x32_bf16 v[124:127], v[132:135], v[200:203], v[124:127]
    v_mfma_f32_16x16x32_bf16 v[96:99], v[128:131], v[176:179], v[96:99]
    ds_read_b64 v[132:133], v4 offset:576
    v_mfma_f32_16x16x32_bf16 v[100:103], v[128:131], v[180:183], v[100:103]
    ds_read_b64 v[134:135], v4 offset:584
    v_mfma_f32_16x16x32_bf16 v[104:107], v[128:131], v[184:187], v[104:107]
    ds_read_b128 v[184:187], v5 offset:2624
    v_mfma_f32_16x16x32_bf16 v[108:111], v[128:131], v[188:191], v[108:111]
    ds_read_b128 v[188:191], v5 offset:2112
    v_mfma_f32_16x16x32_bf16 v[112:115], v[128:131], v[192:195], v[112:115]
    ds_read_b128 v[192:195], v5 offset:1600
    v_mfma_f32_16x16x32_bf16 v[116:119], v[128:131], v[196:199], v[116:119]
    ds_read_b128 v[196:199], v5 offset:1088
    v_mfma_f32_16x16x32_bf16 v[120:123], v[128:131], v[200:203], v[120:123]
    ds_read_b128 v[200:203], v5 offset:576
    v_mfma_f32_16x16x32_bf16 v[124:127], v[128:131], v[204:207], v[124:127]
    ds_read_b128 v[204:207], v5 offset:64
    s_waitcnt lgkmcnt(14)
    v_mfma_f32_16x16x32_bf16 v[124:127], v[156:159], v[208:211], v[124:127]
    ds_read_b64 v[128:129], v4 offset:64
    v_mfma_f32_16x16x32_bf16 v[120:123], v[152:155], v[208:211], v[120:123]
    ds_read_b64 v[130:131], v4 offset:72
    s_waitcnt lgkmcnt(14)
    v_mfma_f32_16x16x32_bf16 v[124:127], v[152:155], v[212:215], v[124:127]
    v_mfma_f32_16x16x32_bf16 v[116:119], v[148:151], v[208:211], v[116:119]
    v_mfma_f32_16x16x32_bf16 v[120:123], v[148:151], v[212:215], v[120:123]
    s_waitcnt lgkmcnt(7)
    v_mfma_f32_16x16x32_bf16 v[124:127], v[148:151], v[184:187], v[124:127]
    v_mfma_f32_16x16x32_bf16 v[112:115], v[144:147], v[208:211], v[112:115]
    v_mfma_f32_16x16x32_bf16 v[116:119], v[144:147], v[212:215], v[116:119]
    v_mfma_f32_16x16x32_bf16 v[120:123], v[144:147], v[184:187], v[120:123]
    s_waitcnt lgkmcnt(6)
    v_mfma_f32_16x16x32_bf16 v[124:127], v[144:147], v[188:191], v[124:127]
    s_waitcnt lgkmcnt(0)
    v_mfma_f32_16x16x32_bf16 v[96:99], v[128:131], v[208:211], v[96:99]
    v_mfma_f32_16x16x32_bf16 v[100:103], v[132:135], v[208:211], v[100:103]
    v_mfma_f32_16x16x32_bf16 v[100:103], v[128:131], v[212:215], v[100:103]
    v_mfma_f32_16x16x32_bf16 v[104:107], v[136:139], v[208:211], v[104:107]
    v_mfma_f32_16x16x32_bf16 v[104:107], v[132:135], v[212:215], v[104:107]
    v_mfma_f32_16x16x32_bf16 v[104:107], v[128:131], v[184:187], v[104:107]
    s_nop 2
    v_cvt_pk_bf16_f32 v16, v96, v97
    v_cvt_pk_bf16_f32 v17, v98, v99
    v_mfma_f32_16x16x32_bf16 v[108:111], v[140:143], v[208:211], v[108:111]
    v_mfma_f32_16x16x32_bf16 v[108:111], v[136:139], v[212:215], v[108:111]
    v_cvt_pk_bf16_f32 v18, v100, v101
    v_cvt_pk_bf16_f32 v19, v102, v103
    v_mfma_f32_16x16x32_bf16 v[108:111], v[132:135], v[184:187], v[108:111]
    v_mfma_f32_16x16x32_bf16 v[108:111], v[128:131], v[188:191], v[108:111]
    v_permlane16_swap_b32 v16, v18
    v_permlane16_swap_b32 v17, v19
    v_mfma_f32_16x16x32_bf16 v[112:115], v[140:143], v[212:215], v[112:115]
    buffer_store_dwordx4 v[16:19], v6, s[76:79], 0 offen
    v_cvt_pk_bf16_f32 v20, v104, v105
    v_cvt_pk_bf16_f32 v21, v106, v107
    v_mfma_f32_16x16x32_bf16 v[112:115], v[136:139], v[184:187], v[112:115]
    v_mfma_f32_16x16x32_bf16 v[112:115], v[132:135], v[188:191], v[112:115]
    v_mfma_f32_16x16x32_bf16 v[112:115], v[128:131], v[192:195], v[112:115]
    v_mfma_f32_16x16x32_bf16 v[116:119], v[140:143], v[184:187], v[116:119]
    v_cvt_pk_bf16_f32 v22, v108, v109
    v_cvt_pk_bf16_f32 v23, v110, v111
    v_mfma_f32_16x16x32_bf16 v[116:119], v[136:139], v[188:191], v[116:119]
    v_mfma_f32_16x16x32_bf16 v[116:119], v[132:135], v[192:195], v[116:119]
    v_permlane16_swap_b32 v20, v22
    v_permlane16_swap_b32 v21, v23
    v_mfma_f32_16x16x32_bf16 v[116:119], v[128:131], v[196:199], v[116:119]
    buffer_store_dwordx4 v[20:23], v6, s[76:79], s87 offen
    v_mfma_f32_16x16x32_bf16 v[120:123], v[140:143], v[188:191], v[120:123]
    v_cvt_pk_bf16_f32 v24, v112, v113
    v_cvt_pk_bf16_f32 v25, v114, v115
    v_mfma_f32_16x16x32_bf16 v[120:123], v[136:139], v[192:195], v[120:123]
    v_mfma_f32_16x16x32_bf16 v[120:123], v[132:135], v[196:199], v[120:123]
    v_mfma_f32_16x16x32_bf16 v[120:123], v[128:131], v[200:203], v[120:123]
    v_mfma_f32_16x16x32_bf16 v[124:127], v[140:143], v[192:195], v[124:127]
    v_cvt_pk_bf16_f32 v26, v116, v117
    v_cvt_pk_bf16_f32 v27, v118, v119
    v_mfma_f32_16x16x32_bf16 v[124:127], v[136:139], v[196:199], v[124:127]
    v_mfma_f32_16x16x32_bf16 v[124:127], v[132:135], v[200:203], v[124:127]
    v_permlane16_swap_b32 v24, v26
    v_permlane16_swap_b32 v25, v27
    v_mfma_f32_16x16x32_bf16 v[124:127], v[128:131], v[204:207], v[124:127]
    buffer_store_dwordx4 v[24:27], v6, s[76:79], s88 offen
    v_cvt_pk_bf16_f32 v28, v120, v121
    v_cvt_pk_bf16_f32 v29, v122, v123
    s_nop 4
    v_cvt_pk_bf16_f32 v30, v124, v125
    v_cvt_pk_bf16_f32 v31, v126, v127
    s_nop 0
    v_permlane16_swap_b32 v28, v30
    v_permlane16_swap_b32 v29, v31
    buffer_store_dwordx4 v[28:31], v6, s[76:79], s89 offen
    s_mov_b64 exec, 1
    s_waitcnt vmcnt(0)
    buffer_store_dwordx2 v[14:15], v1, s[68:71], s7 offen
    s_mov_b64 exec, -1
L_c_ydone:
    s_lshl_b32 s7, s3, 2
    v_mov_b32 v11, s7
    s_mov_b32 s93, 0
L_lw10:
    ds_read_b32 v12, v11 offset:32
    s_waitcnt lgkmcnt(0)
    v_cmp_le_u32 vcc, 1, v12
    s_nop 3
    s_cbranch_vccnz L_lw10_ok
    s_add_u32 s93, s93, 1
    s_sleep 1
    s_cmp_lt_u32 s93, 480000
    s_cbranch_scc1 L_lw10
L_lw10_ok:
    s_mul_i32 s7, s3, 6144
    v_lshlrev_b32 v7, 3, v0
    v_add_u32 v12, s7, v7
    ds_read_b64 v[48:49], v12 offset:15616
    ds_read_b64 v[50:51], v12 offset:16128
    ds_read_b64 v[52:53], v12 offset:16640
    ds_read_b64 v[54:55], v12 offset:17152
    v_add_u32 v12, s7, v91
    ds_read_b128 v[32:35], v12 offset:11520
    ds_read_b128 v[36:39], v12 offset:12544
    ds_read_b128 v[40:43], v12 offset:13568
    ds_read_b128 v[44:47], v12 offset:14592
    ds_read_b128 v[176:179], v1 offset:64
    s_lshl_b32 s7, s4, 10
    s_lshl_b32 s8, s90, 9
    s_add_u32 s7, s7, s8
    s_add_u32 s7, s7, 49152
    s_waitcnt lgkmcnt(0)
    v_readfirstlane_b32 s14, v176
    v_readfirstlane_b32 s15, v177
    s_mov_b32 s98, 0
    buffer_load_dwordx2 v[92:93], v7, s[68:71], s7 offen sc1
    v_lshlrev_b32 v56, 16, v48
    v_and_b32 v57, 0xffff0000, v48
    v_lshlrev_b32 v58, 16, v49
    v_and_b32 v59, 0xffff0000, v49
    v_lshlrev_b32 v60, 16, v50
    v_and_b32 v61, 0xffff0000, v50
    v_lshlrev_b32 v62, 16, v51
    v_and_b32 v63, 0xffff0000, v51
    v_lshlrev_b32 v64, 16, v52
    v_and_b32 v65, 0xffff0000, v52
    v_lshlrev_b32 v66, 16, v53
    v_and_b32 v67, 0xffff0000, v53
    v_lshlrev_b32 v68, 16, v54
    v_and_b32 v69, 0xffff0000, v54
    v_lshlrev_b32 v70, 16, v55
    v_and_b32 v71, 0xffff0000, v55
    v_rcp_f32 v56, v56
    v_rcp_f32 v58, v58
    v_rcp_f32 v60, v60
    v_rcp_f32 v62, v62
    v_rcp_f32 v64, v64
    v_rcp_f32 v66, v66
    v_rcp_f32 v68, v68
    v_rcp_f32 v70, v70
    v_lshlrev_b32 v128, 16, v32
    v_and_b32 v129, 0xffff0000, v32
    v_lshlrev_b32 v130, 16, v33
    v_and_b32 v131, 0xffff0000, v33
    v_lshlrev_b32 v132, 16, v34
    v_and_b32 v133, 0xffff0000, v34
    v_lshlrev_b32 v134, 16, v35
    v_and_b32 v135, 0xffff0000, v35
    v_lshlrev_b32 v136, 16, v36
    v_and_b32 v137, 0xffff0000, v36
    v_lshlrev_b32 v138, 16, v37
    v_and_b32 v139, 0xffff0000, v37
    v_lshlrev_b32 v140, 16, v38
    v_and_b32 v141, 0xffff0000, v38
    v_lshlrev_b32 v142, 16, v39
    v_and_b32 v143, 0xffff0000, v39
    v_lshlrev_b32 v144, 16, v40
    v_and_b32 v145, 0xffff0000, v40
    v_lshlrev_b32 v146, 16, v41
    v_and_b32 v147, 0xffff0000, v41
    v_lshlrev_b32 v148, 16, v42
    v_and_b32 v149, 0xffff0000, v42
    v_lshlrev_b32 v150, 16, v43
    v_and_b32 v151, 0xffff0000, v43
    v_lshlrev_b32 v152, 16, v44
    v_and_b32 v153, 0xffff0000, v44
    v_lshlrev_b32 v154, 16, v45
    v_and_b32 v155, 0xffff0000, v45
    v_lshlrev_b32 v156, 16, v46
    v_and_b32 v157, 0xffff0000, v46
    v_lshlrev_b32 v158, 16, v47
    v_and_b32 v159, 0xffff0000, v47
    v_mul_f32 v57, -v57, v56
    v_mul_f32 v59, -v59, v58
    v_mul_f32 v61, -v61, v60
    v_mul_f32 v63, -v63, v62
    v_mul_f32 v65, -v65, v64
    v_mul_f32 v67, -v67, v66
    v_mul_f32 v69, -v69, v68
    v_mul_f32 v71, -v71, v70
    v_pk_fma_f32 v[96:97], v[128:129], v[56:57], v[56:57] op_sel:[0,0,1] op_sel_hi:[1,0,1]
    v_pk_fma_f32 v[98:99], v[130:131], v[56:57], v[56:57] op_sel:[0,0,1] op_sel_hi:[1,0,1]
    v_pk_fma_f32 v[100:101], v[132:133], v[58:59], v[58:59] op_sel:[0,0,1] op_sel_hi:[1,0,1]
    v_pk_fma_f32 v[102:103], v[134:135], v[58:59], v[58:59] op_sel:[0,0,1] op_sel_hi:[1,0,1]
    v_pk_fma_f32 v[104:105], v[136:137], v[60:61], v[60:61] op_sel:[0,0,1] op_sel_hi:[1,0,1]
    v_pk_fma_f32 v[106:107], v[138:139], v[60:61], v[60:61] op_sel:[0,0,1] op_sel_hi:[1,0,1]
    v_pk_fma_f32 v[108:109], v[140:141], v[62:63], v[62:63] op_sel:[0,0,1] op_sel_hi:[1,0,1]
    v_pk_fma_f32 v[110:111], v[142:143], v[62:63], v[62:63] op_sel:[0,0,1] op_sel_hi:[1,0,1]
    v_pk_fma_f32 v[112:113], v[144:145], v[64:65], v[64:65] op_sel:[0,0,1] op_sel_hi:[1,0,1]
    v_pk_fma_f32 v[114:115], v[146:147], v[64:65], v[64:65] op_sel:[0,0,1] op_sel_hi:[1,0,1]
    v_pk_fma_f32 v[116:117], v[148:149], v[66:67], v[66:67] op_sel:[0,0,1] op_sel_hi:[1,0,1]
    v_pk_fma_f32 v[118:119], v[150:151], v[66:67], v[66:67] op_sel:[0,0,1] op_sel_hi:[1,0,1]
    v_pk_fma_f32 v[120:121], v[152:153], v[68:69], v[68:69] op_sel:[0,0,1] op_sel_hi:[1,0,1]
    v_pk_fma_f32 v[122:123], v[154:155], v[68:69], v[68:69] op_sel:[0,0,1] op_sel_hi:[1,0,1]
    v_pk_fma_f32 v[124:125], v[156:157], v[70:71], v[70:71] op_sel:[0,0,1] op_sel_hi:[1,0,1]
    v_pk_fma_f32 v[126:127], v[158:159], v[70:71], v[70:71] op_sel:[0,0,1] op_sel_hi:[1,0,1]
    v_pk_add_f32 v[128:129], v[128:129], v[96:97]
    v_pk_add_f32 v[130:131], v[130:131], v[98:99]
    v_pk_add_f32 v[132:133], v[132:133], v[100:101]
    v_pk_add_f32 v[134:135], v[134:135], v[102:103]
    v_pk_add_f32 v[136:137], v[136:137], v[104:105]
    v_pk_add_f32 v[138:139], v[138:139], v[106:107]
    v_pk_add_f32 v[140:141], v[140:141], v[108:109]
    v_pk_add_f32 v[142:143], v[142:143], v[110:111]
    v_pk_add_f32 v[144:145], v[144:145], v[112:113]
    v_pk_add_f32 v[146:147], v[146:147], v[114:115]
    v_pk_add_f32 v[148:149], v[148:149], v[116:117]
    v_pk_add_f32 v[150:151], v[150:151], v[118:119]
    v_pk_add_f32 v[152:153], v[152:153], v[120:121]
    v_pk_add_f32 v[154:155], v[154:155], v[122:123]
    v_pk_add_f32 v[156:157], v[156:157], v[124:125]
    v_pk_add_f32 v[158:159], v[158:159], v[126:127]
    s_mov_b32 s93, 0
    s_cmp_eq_u32 s98, 1
    s_cbranch_scc1 L_c_yok2
L_c_polly:
    s_waitcnt vmcnt(0)
    v_cmp_ne_u64 vcc, v[92:93], v[14:15]
    s_nop 3
    s_cbranch_vccz L_c_yok
    buffer_load_dwordx2 v[92:93], v7, s[68:71], s7 offen sc1
    s_add_u32 s93, s93, 1
    s_cmp_lt_u32 s93, 240000
    s_cbranch_scc1 L_c_polly
L_c_yok:
    buffer_load_dwordx4 v[160:163], v3, s[76:79], 0 offen sc1
    buffer_load_dwordx4 v[164:167], v3, s[76:79], 0 offen offset:64 sc1
    buffer_load_dwordx4 v[168:171], v3, s[76:79], 0 offen offset:2048 sc1
    buffer_load_dwordx4 v[172:175], v3, s[76:79], 0 offen offset:2112 sc1
L_c_yok2:
    s_and_b32 s14, s14, 0x7ff
    s_sub_u32 s14, 2047, s14
    s_and_b32 s15, s15, 0x7ff
    s_sub_u32 s15, 2047, s15
    s_lshl_b32 s12, s5, 1
    s_add_u32 s12, s12, s91
    s_lshr_b32 s8, s14, 5
    s_lshr_b32 s9, s15, 5
    s_cmp_eq_u32 s8, s12
    s_cbranch_scc1 L_c_spec
    s_cmp_eq_u32 s9, s12
    s_cbranch_scc1 L_c_spec
    s_waitcnt vmcnt(0)
    v_lshlrev_b32 v176, 16, v160
    v_and_b32 v180, 0xffff0000, v160
    v_lshlrev_b32 v177, 16, v164
    v_and_b32 v181, 0xffff0000, v164
    v_lshlrev_b32 v178, 16, v168
    v_and_b32 v182, 0xffff0000, v168
    v_lshlrev_b32 v179, 16, v172
    v_and_b32 v183, 0xffff0000, v172
    v_pk_fma_f32 v[128:129], v[176:177], v[96:97], v[128:129]
    v_pk_fma_f32 v[130:131], v[178:179], v[98:99], v[130:131]
    v_pk_fma_f32 v[132:133], v[180:181], v[100:101], v[132:133]
    v_pk_fma_f32 v[134:135], v[182:183], v[102:103], v[134:135]
    v_cvt_pk_bf16_f32 v16, v128, v129
    v_cvt_pk_bf16_f32 v17, v130, v131
    v_cvt_pk_bf16_f32 v18, v132, v133
    v_cvt_pk_bf16_f32 v19, v134, v135
    buffer_store_dwordx2 v[16:17], v2, s[64:67], 0 offen
    buffer_store_dwordx2 v[18:19], v2, s[64:67], 0 offen offset:2048
    v_lshlrev_b32 v184, 16, v161
    v_and_b32 v188, 0xffff0000, v161
    v_lshlrev_b32 v185, 16, v165
    v_and_b32 v189, 0xffff0000, v165
    v_lshlrev_b32 v186, 16, v169
    v_and_b32 v190, 0xffff0000, v169
    v_lshlrev_b32 v187, 16, v173
    v_and_b32 v191, 0xffff0000, v173
    v_pk_fma_f32 v[136:137], v[184:185], v[104:105], v[136:137]
    v_pk_fma_f32 v[138:139], v[186:187], v[106:107], v[138:139]
    v_pk_fma_f32 v[140:141], v[188:189], v[108:109], v[140:141]
    v_pk_fma_f32 v[142:143], v[190:191], v[110:111], v[142:143]
    v_cvt_pk_bf16_f32 v20, v136, v137
    v_cvt_pk_bf16_f32 v21, v138, v139
    v_cvt_pk_bf16_f32 v22, v140, v141
    v_cvt_pk_bf16_f32 v23, v142, v143
    buffer_store_dwordx2 v[20:21], v2, s[64:67], s84 offen
    buffer_store_dwordx2 v[22:23], v2, s[64:67], s84 offen offset:2048
    v_lshlrev_b32 v176, 16, v162
    v_and_b32 v180, 0xffff0000, v162
    v_lshlrev_b32 v177, 16, v166
    v_and_b32 v181, 0xffff0000, v166
    v_lshlrev_b32 v178, 16, v170
    v_and_b32 v182, 0xffff0000, v170
    v_lshlrev_b32 v179, 16, v174
    v_and_b32 v183, 0xffff0000, v174
    v_pk_fma_f32 v[144:145], v[176:177], v[112:113], v[144:145]
    v_pk_fma_f32 v[146:147], v[178:179], v[114:115], v[146:147]
    v_pk_fma_f32 v[148:149], v[180:181], v[116:117], v[148:149]
    v_pk_fma_f32 v[150:151], v[182:183], v[118:119], v[150:151]
    v_cvt_pk_bf16_f32 v24, v144, v145
    v_cvt_pk_bf16_f32 v25, v146, v147
    v_cvt_pk_bf16_f32 v26, v148, v149
    v_cvt_pk_bf16_f32 v27, v150, v151
    buffer_store_dwordx2 v[24:25], v2, s[64:67], s85 offen
    buffer_store_dwordx2 v[26:27], v2, s[64:67], s85 offen offset:2048
    v_lshlrev_b32 v184, 16, v163
    v_and_b32 v188, 0xffff0000, v163
    v_lshlrev_b32 v185, 16, v167
    v_and_b32 v189, 0xffff0000, v167
    v_lshlrev_b32 v186, 16, v171
    v_and_b32 v190, 0xffff0000, v171
    v_lshlrev_b32 v187, 16, v175
    v_and_b32 v191, 0xffff0000, v175
    v_pk_fma_f32 v[152:153], v[184:185], v[120:121], v[152:153]
    v_pk_fma_f32 v[154:155], v[186:187], v[122:123], v[154:155]
    v_pk_fma_f32 v[156:157], v[188:189], v[124:125], v[156:157]
    v_pk_fma_f32 v[158:159], v[190:191], v[126:127], v[158:159]
    v_cvt_pk_bf16_f32 v28, v152, v153
    v_cvt_pk_bf16_f32 v29, v154, v155
    v_cvt_pk_bf16_f32 v30, v156, v157
    v_cvt_pk_bf16_f32 v31, v158, v159
    buffer_store_dwordx2 v[28:29], v2, s[64:67], s86 offen
    buffer_store_dwordx2 v[30:31], v2, s[64:67], s86 offen offset:2048
    s_branch L_c_done
L_c_spec:
    v_lshlrev_b32 v12, 11, v10
    v_lshl_add_u32 v12, v9, 4, v12
    v_add_u32 v12, s10, v12
    s_lshl_b32 s12, s12, 5
    v_lshl_add_u32 v8, v10, 3, s12
    v_sub_u32 v4, s14, v8
    v_sub_u32 v5, s15, v8
    s_waitcnt vmcnt(0)
    v_lshlrev_b32 v176, 16, v160
    v_and_b32 v180, 0xffff0000, v160
    v_lshlrev_b32 v177, 16, v164
    v_and_b32 v181, 0xffff0000, v164
    v_lshlrev_b32 v178, 16, v168
    v_and_b32 v182, 0xffff0000, v168
    v_lshlrev_b32 v179, 16, v172
    v_and_b32 v183, 0xffff0000, v172
    v_pk_fma_f32 v[128:129], v[176:177], v[96:97], v[128:129]
    v_pk_fma_f32 v[130:131], v[178:179], v[98:99], v[130:131]
    v_pk_fma_f32 v[132:133], v[180:181], v[100:101], v[132:133]
    v_pk_fma_f32 v[134:135], v[182:183], v[102:103], v[134:135]
    ds_write_b128 v12, v[128:131] offset:0
    ds_write_b128 v12, v[132:135] offset:256
    v_lshlrev_b32 v184, 16, v161
    v_and_b32 v188, 0xffff0000, v161
    v_lshlrev_b32 v185, 16, v165
    v_and_b32 v189, 0xffff0000, v165
    v_lshlrev_b32 v186, 16, v169
    v_and_b32 v190, 0xffff0000, v169
    v_lshlrev_b32 v187, 16, v173
    v_and_b32 v191, 0xffff0000, v173
    v_pk_fma_f32 v[136:137], v[184:185], v[104:105], v[136:137]
    v_pk_fma_f32 v[138:139], v[186:187], v[106:107], v[138:139]
    v_pk_fma_f32 v[140:141], v[188:189], v[108:109], v[140:141]
    v_pk_fma_f32 v[142:143], v[190:191], v[110:111], v[142:143]
    ds_write_b128 v12, v[136:139] offset:512
    ds_write_b128 v12, v[140:143] offset:768
    v_lshlrev_b32 v176, 16, v162
    v_and_b32 v180, 0xffff0000, v162
    v_lshlrev_b32 v177, 16, v166
    v_and_b32 v181, 0xffff0000, v166
    v_lshlrev_b32 v178, 16, v170
    v_and_b32 v182, 0xffff0000, v170
    v_lshlrev_b32 v179, 16, v174
    v_and_b32 v183, 0xffff0000, v174
    v_pk_fma_f32 v[144:145], v[176:177], v[112:113], v[144:145]
    v_pk_fma_f32 v[146:147], v[178:179], v[114:115], v[146:147]
    v_pk_fma_f32 v[148:149], v[180:181], v[116:117], v[148:149]
    v_pk_fma_f32 v[150:151], v[182:183], v[118:119], v[150:151]
    ds_write_b128 v12, v[144:147] offset:1024
    ds_write_b128 v12, v[148:151] offset:1280
    v_lshlrev_b32 v184, 16, v163
    v_and_b32 v188, 0xffff0000, v163
    v_lshlrev_b32 v185, 16, v167
    v_and_b32 v189, 0xffff0000, v167
    v_lshlrev_b32 v186, 16, v171
    v_and_b32 v190, 0xffff0000, v171
    v_lshlrev_b32 v187, 16, v175
    v_and_b32 v191, 0xffff0000, v175
    v_pk_fma_f32 v[152:153], v[184:185], v[120:121], v[152:153]
    v_pk_fma_f32 v[154:155], v[186:187], v[122:123], v[154:155]
    v_pk_fma_f32 v[156:157], v[188:189], v[124:125], v[156:157]
    v_pk_fma_f32 v[158:159], v[190:191], v[126:127], v[158:159]
    ds_write_b128 v12, v[152:155] offset:1536
    ds_write_b128 v12, v[156:159] offset:1792
    s_mov_b64 exec, 1
    ds_add_u32 v11, v13 offset:48
    s_mov_b64 exec, -1
    v_cvt_pk_bf16_f32 v16, v128, v129
    v_cvt_pk_bf16_f32 v17, v130, v131
    v_cvt_pk_bf16_f32 v18, v132, v133
    v_cvt_pk_bf16_f32 v19, v134, v135
    v_cvt_pk_bf16_f32 v20, v136, v137
    v_cvt_pk_bf16_f32 v21, v138, v139
    v_cvt_pk_bf16_f32 v22, v140, v141
    v_cvt_pk_bf16_f32 v23, v142, v143
    v_cvt_pk_bf16_f32 v24, v144, v145
    v_cvt_pk_bf16_f32 v25, v146, v147
    v_cvt_pk_bf16_f32 v26, v148, v149
    v_cvt_pk_bf16_f32 v27, v150, v151
    v_cvt_pk_bf16_f32 v28, v152, v153
    v_cvt_pk_bf16_f32 v29, v154, v155
    v_cvt_pk_bf16_f32 v30, v156, v157
    v_cvt_pk_bf16_f32 v31, v158, v159
    v_cmp_ne_u32 vcc, 0, v4
    v_cmp_ne_u32 s[8:9], 0, v5
    s_nop 0
    s_and_b64 exec, vcc, s[8:9]
    buffer_store_dwordx2 v[16:17], v2, s[64:67], 0 offen
    s_mov_b64 exec, -1
    v_cmp_ne_u32 vcc, 1, v4
    v_cmp_ne_u32 s[8:9], 1, v5
    s_nop 0
    s_and_b64 exec, vcc, s[8:9]
    buffer_store_dwordx2 v[18:19], v2, s[64:67], 0 offen offset:2048
    s_mov_b64 exec, -1
    v_cmp_ne_u32 vcc, 2, v4
    v_cmp_ne_u32 s[8:9], 2, v5
    s_nop 0
    s_and_b64 exec, vcc, s[8:9]
    buffer_store_dwordx2 v[20:21], v2, s[64:67], s84 offen
    s_mov_b64 exec, -1
    v_cmp_ne_u32 vcc, 3, v4
    v_cmp_ne_u32 s[8:9], 3, v5
    s_nop 0
    s_and_b64 exec, vcc, s[8:9]
    buffer_store_dwordx2 v[22:23], v2, s[64:67], s84 offen offset:2048
    s_mov_b64 exec, -1
    v_cmp_ne_u32 vcc, 4, v4
    v_cmp_ne_u32 s[8:9], 4, v5
    s_nop 0
    s_and_b64 exec, vcc, s[8:9]
    buffer_store_dwordx2 v[24:25], v2, s[64:67], s85 offen
    s_mov_b64 exec, -1
    v_cmp_ne_u32 vcc, 5, v4
    v_cmp_ne_u32 s[8:9], 5, v5
    s_nop 0
    s_and_b64 exec, vcc, s[8:9]
    buffer_store_dwordx2 v[26:27], v2, s[64:67], s85 offen offset:2048
    s_mov_b64 exec, -1
    v_cmp_ne_u32 vcc, 6, v4
    v_cmp_ne_u32 s[8:9], 6, v5
    s_nop 0
    s_and_b64 exec, vcc, s[8:9]
    buffer_store_dwordx2 v[28:29], v2, s[64:67], s86 offen
    s_mov_b64 exec, -1
    v_cmp_ne_u32 vcc, 7, v4
    v_cmp_ne_u32 s[8:9], 7, v5
    s_nop 0
    s_and_b64 exec, vcc, s[8:9]
    buffer_store_dwordx2 v[30:31], v2, s[64:67], s86 offen offset:2048
    s_mov_b64 exec, -1
    s_waitcnt lgkmcnt(0)
L_c_done:
    s_endpgm
L_M2:
    s_mov_b32 s60, s42
    s_and_b32 s61, s43, 0xffff
    s_mov_b32 s62, 268435456
    s_mov_b32 s63, 0x20000
    s_mov_b32 s56, s36
    s_and_b32 s57, s37, 0xffff
    s_mov_b32 s58, 7340032
    s_mov_b32 s59, 0x20000
    s_mov_b32 s68, s38
    s_and_b32 s69, s39, 0xffff
    s_mov_b32 s70, 4194304
    s_mov_b32 s71, 0x20000
    s_mov_b32 s93, s2
    s_and_b32 s72, s93, 3
    s_lshr_b32 s9, s93, 2
    s_and_b32 s73, s9, 1
    s_lshr_b32 s74, s9, 1
    s_cmp_eq_u32 s73, 0
    s_cselect_b32 s52, s32, s34
    s_cselect_b32 s53, s33, s35
    s_and_b32 s53, s53, 0xffff
    s_cmp_lt_u32 s93, 224
    s_cselect_b32 s54, 7340032, 0
    s_mov_b32 s55, 0x20000
    s_lshl_b32 s9, s72, 8
    s_lshl_b32 s8, s3, 6
    s_add_u32 s9, s9, s8
    s_mul_i32 s9, s9, 7168
    s_lshl_b32 s8, s74, 8
    s_add_u32 s79, s9, s8
    v_and_b32 v5, 7, v0
    v_and_b32 v6, 1, v0
    v_lshlrev_b32 v6, 4, v6
    v_mov_b32 v88, 0xffff
    v_lshlrev_b32 v6, v6, v88
    v_lshrrev_b32 v88, 1, v5
    v_cmp_eq_u32 vcc, 0, v88
    s_nop 1
    v_cndmask_b32 v196, 0, v6, vcc
    v_cmp_eq_u32 vcc, 1, v88
    s_nop 1
    v_cndmask_b32 v197, 0, v6, vcc
    v_cmp_eq_u32 vcc, 2, v88
    s_nop 1
    v_cndmask_b32 v198, 0, v6, vcc
    v_cmp_eq_u32 vcc, 3, v88
    s_nop 1
    v_cndmask_b32 v199, 0, v6, vcc
    v_lshrrev_b32 v6, 3, v9
    v_lshlrev_b32 v240, 8, v10
    v_lshl_add_u32 v240, v5, 3, v240
    v_lshl_add_u32 v240, v6, 2, v240
    v_lshlrev_b32 v241, 7, v10
    v_lshl_add_u32 v241, v5, 2, v241
    v_lshl_add_u32 v241, v6, 9, v241
    s_lshl_b32 s7, s3, 10
    v_add_u32 v240, s7, v240
    v_add_u32 v241, s7, v241
    s_lshl_b32 s7, s3, 8
    v_lshlrev_b32 v243, 7, v6
    v_lshl_add_u32 v243, v10, 5, v243
    v_add_u32 v243, s7, v243
    v_lshrrev_b32 v88, 1, v0
    v_min_u32 v88, 27, v88
    v_and_b32 v242, 3, v88
    v_lshlrev_b32 v242, 5, v242
    v_lshrrev_b32 v89, 2, v88
    v_lshl_add_u32 v242, v89, 2, v242
    v_add_u32 v242, s7, v242
    v_and_b32 v245, 1, v0
    v_mul_u32_u24 v245, 14336, v245
    v_add_u32 v245, v245, v88
    v_lshrrev_b32 v245, 1, v245
    v_and_b32 v246, 1, v88
    v_lshlrev_b32 v245, 4, v245
    v_mul_u32_u24 v7, 114688, v10
    v_lshl_add_u32 v7, v9, 4, v7
    s_mul_i32 s7, s5, 112
    s_mul_i32 s8, s3, 28
    s_add_u32 s14, s7, s8
    s_lshl_b32 s7, s14, 11
    s_lshl_b32 s8, s4, 8
    s_add_u32 s92, s7, s8
    v_lshlrev_b32 v8, 11, v10
    v_lshl_add_u32 v8, v9, 4, v8
    s_mul_i32 s80, s14, 8
    s_add_u32 s80, s80, 65536
    s_add_u32 s81, s80, 28672
    s_add_u32 s82, s80, 57344
    s_add_u32 s83, s80, 86016
    s_lshl_b32 s7, s2, 3
    s_lshl_b32 s8, s3, 1
    s_add_u32 s7, s7, s8
    s_sub_u32 s10, 2047, s7
    s_sub_u32 s11, 2046, s7
    v_mov_b32 v40, 0x3f803f80
    s_lshl_b32 s15, s5, 9
    s_lshl_b32 s7, s91, 8
    s_add_u32 s15, s15, s7
    s_add_u32 s15, s15, 8192
    v_lshlrev_b32 v11, 6, v10
    s_lshl_b32 s7, s4, 6
    s_add_u32 s7, s7, s5
    s_lshl_b32 s7, s7, 10
    s_add_u32 s12, s7, 524288
    s_add_u32 s13, s12, 32768
    v_lshlrev_b32 v244, 7, v5
    v_lshl_add_u32 v244, v6, 15, v244
    s_lshl_b32 s7, s2, 6
    s_add_u32 s7, s7, 8192
    v_and_b32 v5, 3, v0
    v_lshlrev_b32 v236, 4, v5
    v_add_u32 v236, s7, v236
    s_lshl_b32 s7, s2, 4
    v_mov_b32 v6, s7
    v_cmp_eq_u32 vcc, 4, v0
    s_nop 1
    v_cndmask_b32 v236, v236, v6, vcc
    v_lshlrev_b32 v237, 3, v5
    s_lshl_b32 s8, s3, 3
    v_mov_b32 v5, s8
    s_setprio 2
    s_waitcnt vmcnt(0)
    v_dot2_f32_bf16 v88, v16, v40, 0
    v_dot2_f32_bf16 v90, v16, v16, 0
    v_dot2_f32_bf16 v92, v16, v32, 0
    v_dot2_f32_bf16 v89, v24, v40, 0
    v_dot2_f32_bf16 v91, v24, v24, 0
    v_dot2_f32_bf16 v93, v24, v32, 0
    v_dot2_f32_bf16 v94, v32, v40, 0
    v_dot2_f32_bf16 v88, v17, v40, v88
    v_dot2_f32_bf16 v90, v17, v17, v90
    v_dot2_f32_bf16 v92, v17, v33, v92
    v_dot2_f32_bf16 v89, v25, v40, v89
    v_dot2_f32_bf16 v91, v25, v25, v91
    v_dot2_f32_bf16 v93, v25, v33, v93
    v_dot2_f32_bf16 v94, v33, v40, v94
    v_dot2_f32_bf16 v88, v18, v40, v88
    v_dot2_f32_bf16 v90, v18, v18, v90
    v_dot2_f32_bf16 v92, v18, v34, v92
    v_dot2_f32_bf16 v89, v26, v40, v89
    v_dot2_f32_bf16 v91, v26, v26, v91
    v_dot2_f32_bf16 v93, v26, v34, v93
    v_dot2_f32_bf16 v94, v34, v40, v94
    v_dot2_f32_bf16 v88, v19, v40, v88
    v_dot2_f32_bf16 v90, v19, v19, v90
    v_dot2_f32_bf16 v92, v19, v35, v92
    v_dot2_f32_bf16 v89, v27, v40, v89
    v_dot2_f32_bf16 v91, v27, v27, v91
    v_dot2_f32_bf16 v93, v27, v35, v93
    v_dot2_f32_bf16 v94, v35, v40, v94
    v_dot2_f32_bf16 v88, v20, v40, v88
    v_dot2_f32_bf16 v90, v20, v20, v90
    v_dot2_f32_bf16 v92, v20, v36, v92
    v_dot2_f32_bf16 v89, v28, v40, v89
    v_dot2_f32_bf16 v91, v28, v28, v91
    v_dot2_f32_bf16 v93, v28, v36, v93
    v_dot2_f32_bf16 v94, v36, v40, v94
    v_dot2_f32_bf16 v88, v21, v40, v88
    v_dot2_f32_bf16 v90, v21, v21, v90
    v_dot2_f32_bf16 v92, v21, v37, v92
    v_dot2_f32_bf16 v89, v29, v40, v89
    v_dot2_f32_bf16 v91, v29, v29, v91
    v_dot2_f32_bf16 v93, v29, v37, v93
    v_dot2_f32_bf16 v94, v37, v40, v94
    v_dot2_f32_bf16 v88, v22, v40, v88
    v_dot2_f32_bf16 v90, v22, v22, v90
    v_dot2_f32_bf16 v92, v22, v38, v92
    v_dot2_f32_bf16 v89, v30, v40, v89
    v_dot2_f32_bf16 v91, v30, v30, v91
    v_dot2_f32_bf16 v93, v30, v38, v93
    v_dot2_f32_bf16 v94, v38, v40, v94
    v_dot2_f32_bf16 v88, v23, v40, v88
    v_dot2_f32_bf16 v90, v23, v23, v90
    v_dot2_f32_bf16 v92, v23, v39, v92
    v_dot2_f32_bf16 v89, v31, v40, v89
    v_dot2_f32_bf16 v91, v31, v31, v91
    v_dot2_f32_bf16 v93, v31, v39, v93
    v_dot2_f32_bf16 v94, v39, v40, v94
    s_memrealtime s[94:95]
    v_add_f32_dpp v88, v88, v88 quad_perm:[1,0,3,2] row_mask:0xf bank_mask:0xf
    v_add_f32_dpp v89, v89, v89 quad_perm:[1,0,3,2] row_mask:0xf bank_mask:0xf
    v_add_f32_dpp v90, v90, v90 quad_perm:[1,0,3,2] row_mask:0xf bank_mask:0xf
    v_add_f32_dpp v91, v91, v91 quad_perm:[1,0,3,2] row_mask:0xf bank_mask:0xf
    v_add_f32_dpp v92, v92, v92 quad_perm:[1,0,3,2] row_mask:0xf bank_mask:0xf
    v_add_f32_dpp v93, v93, v93 quad_perm:[1,0,3,2] row_mask:0xf bank_mask:0xf
    v_add_f32_dpp v94, v94, v94 quad_perm:[1,0,3,2] row_mask:0xf bank_mask:0xf
    v_add_f32_dpp v88, v88, v88 quad_perm:[2,3,0,1] row_mask:0xf bank_mask:0xf
    v_add_f32_dpp v89, v89, v89 quad_perm:[2,3,0,1] row_mask:0xf bank_mask:0xf
    v_add_f32_dpp v90, v90, v90 quad_perm:[2,3,0,1] row_mask:0xf bank_mask:0xf
    v_add_f32_dpp v91, v91, v91 quad_perm:[2,3,0,1] row_mask:0xf bank_mask:0xf
    v_add_f32_dpp v92, v92, v92 quad_perm:[2,3,0,1] row_mask:0xf bank_mask:0xf
    v_add_f32_dpp v93, v93, v93 quad_perm:[2,3,0,1] row_mask:0xf bank_mask:0xf
    v_add_f32_dpp v94, v94, v94 quad_perm:[2,3,0,1] row_mask:0xf bank_mask:0xf
    v_add_f32_dpp v88, v88, v88 row_half_mirror row_mask:0xf bank_mask:0xf
    v_add_f32_dpp v89, v89, v89 row_half_mirror row_mask:0xf bank_mask:0xf
    v_add_f32_dpp v90, v90, v90 row_half_mirror row_mask:0xf bank_mask:0xf
    v_add_f32_dpp v91, v91, v91 row_half_mirror row_mask:0xf bank_mask:0xf
    v_add_f32_dpp v92, v92, v92 row_half_mirror row_mask:0xf bank_mask:0xf
    v_add_f32_dpp v93, v93, v93 row_half_mirror row_mask:0xf bank_mask:0xf
    v_add_f32_dpp v94, v94, v94 row_half_mirror row_mask:0xf bank_mask:0xf
    v_add_f32_dpp v88, v88, v88 row_mirror row_mask:0xf bank_mask:0xf
    v_add_f32_dpp v89, v89, v89 row_mirror row_mask:0xf bank_mask:0xf
    v_add_f32_dpp v90, v90, v90 row_mirror row_mask:0xf bank_mask:0xf
    v_add_f32_dpp v91, v91, v91 row_mirror row_mask:0xf bank_mask:0xf
    v_add_f32_dpp v92, v92, v92 row_mirror row_mask:0xf bank_mask:0xf
    v_add_f32_dpp v93, v93, v93 row_mirror row_mask:0xf bank_mask:0xf
    v_add_f32_dpp v94, v94, v94 row_mirror row_mask:0xf bank_mask:0xf
    v_mov_b32 v42, v88
    v_mov_b32 v43, v89
    v_mov_b32 v44, v90
    v_mov_b32 v45, v91
    v_mov_b32 v46, v92
    v_mov_b32 v47, v93
    v_mov_b32 v48, v94
    v_permlane16_swap_b32 v42, v88
    v_permlane16_swap_b32 v43, v89
    v_permlane16_swap_b32 v44, v90
    v_permlane16_swap_b32 v45, v91
    v_permlane16_swap_b32 v46, v92
    v_permlane16_swap_b32 v47, v93
    v_permlane16_swap_b32 v48, v94
    v_add_f32 v88, v88, v42
    v_add_f32 v89, v89, v43
    v_add_f32 v90, v90, v44
    v_add_f32 v91, v91, v45
    v_add_f32 v92, v92, v46
    v_add_f32 v93, v93, v47
    v_add_f32 v94, v94, v48
    v_mov_b32 v42, v88
    v_mov_b32 v43, v89
    v_mov_b32 v44, v90
    v_mov_b32 v45, v91
    v_mov_b32 v46, v92
    v_mov_b32 v47, v93
    v_mov_b32 v48, v94
    v_permlane32_swap_b32 v42, v88
    v_permlane32_swap_b32 v43, v89
    v_permlane32_swap_b32 v44, v90
    v_permlane32_swap_b32 v45, v91
    v_permlane32_swap_b32 v46, v92
    v_permlane32_swap_b32 v47, v93
    v_permlane32_swap_b32 v48, v94
    v_add_f32 v88, v88, v42
    v_add_f32 v89, v89, v43
    v_add_f32 v90, v90, v44
    v_add_f32 v91, v91, v45
    v_add_f32 v92, v92, v46
    v_add_f32 v93, v93, v47
    v_add_f32 v94, v94, v48
    v_mul_f32 v88, 0x3a800000, v88
    v_mul_f32 v90, 0x3a800000, v90
    v_mul_f32 v89, 0x3a800000, v89
    v_mul_f32 v91, 0x3a800000, v91
    v_fma_f32 v90, -v88, v88, v90
    v_max_f32 v90, 0, v90
    v_fma_f32 v91, -v89, v89, v91
    v_max_f32 v91, 0, v91
    v_cvt_pk_bf16_f32 v96, v90, v91
    v_lshlrev_b32 v90, 16, v96
    v_and_b32 v91, 0xffff0000, v96
    v_cvt_pk_bf16_f32 v97, v88, v89
    v_lshlrev_b32 v88, 16, v97
    v_and_b32 v89, 0xffff0000, v97
    v_add_f32 v90, 0x3727c5ac, v90
    v_add_f32 v91, 0x3727c5ac, v91
    v_cvt_pk_bf16_f32 v96, v90, v91
    v_lshlrev_b32 v90, 16, v96
    v_and_b32 v91, 0xffff0000, v96
    v_sqrt_f32 v90, v90
    v_sqrt_f32 v91, v91
    s_nop 0
    v_cvt_pk_bf16_f32 v96, v90, v91
    v_lshlrev_b32 v90, 16, v96
    v_and_b32 v91, 0xffff0000, v96
    v_rcp_f32 v98, v90
    v_fma_f32 v92, -v88, v94, v92
    v_rcp_f32 v99, v91
    v_fma_f32 v93, -v89, v94, v93
    v_lshrrev_b32 v212, 16, v90
    v_or_b32 v212, v212, v88
    v_mul_f32 v92, v92, v98
    v_lshrrev_b32 v213, 16, v91
    v_or_b32 v213, v213, v89
    v_mul_f32 v93, v93, v99
    v_cvt_pk_bf16_f32 v96, v92, v93
    v_lshlrev_b32 v92, 16, v96
    v_and_b32 v93, 0xffff0000, v96
    v_ashrrev_i32 v96, 31, v92
    v_or_b32 v96, 0x80000000, v96
    v_xor_b32 v92, v92, v96
    v_and_b32 v92, 0xffff0000, v92
    v_or_b32 v92, s10, v92
    v_ashrrev_i32 v96, 31, v93
    v_or_b32 v96, 0x80000000, v96
    v_xor_b32 v93, v93, v96
    v_and_b32 v93, 0xffff0000, v93
    v_or_b32 v93, s11, v93
    s_mov_b64 exec, 1
    ds_write_b64 v5, v[92:93] offset:96
    ds_write_b64 v5, v[212:213] offset:128
    s_mov_b64 exec, 1
    ds_add_rtn_u32 v90, v1, v13
    s_waitcnt lgkmcnt(0)
    s_mov_b64 exec, -1
    v_readfirstlane_b32 s78, v90
    s_nop 0
    s_cmp_eq_u32 s78, 3
    s_nop 1
    s_cbranch_scc1 L_m_ctrl
    s_setprio 0
    s_mov_b32 s75, 0
L_lw1:
    ds_read_b32 v6, v1 offset:20
    s_waitcnt lgkmcnt(0)
    v_cmp_le_u32 vcc, 4, v6
    s_nop 3
    s_cbranch_vccnz L_lw1_ok
    s_add_u32 s75, s75, 1
    s_sleep 1
    s_cmp_lt_u32 s75, 480000
    s_cbranch_scc1 L_lw1
L_lw1_ok:
    buffer_load_dwordx4 v[104:107], v7, s[52:55], s79 offen nt
    s_add_u32 s79, s79, 7168
    buffer_load_dwordx4 v[108:111], v7, s[52:55], s79 offen nt
    s_add_u32 s79, s79, 7168
    buffer_load_dwordx4 v[112:115], v7, s[52:55], s79 offen nt
    s_add_u32 s79, s79, 7168
    buffer_load_dwordx4 v[116:119], v7, s[52:55], s79 offen nt
    s_add_u32 s79, s79, 7168
    buffer_load_dwordx4 v[120:123], v7, s[52:55], s79 offen nt
    s_add_u32 s79, s79, 7168
    buffer_load_dwordx4 v[124:127], v7, s[52:55], s79 offen nt
    s_add_u32 s79, s79, 7168
    buffer_load_dwordx4 v[128:131], v7, s[52:55], s79 offen nt
    s_add_u32 s79, s79, 7168
    buffer_load_dwordx4 v[132:135], v7, s[52:55], s79 offen nt
    s_add_u32 s79, s79, 7168
    buffer_load_dwordx4 v[136:139], v7, s[52:55], s79 offen nt
    s_add_u32 s79, s79, 7168
    buffer_load_dwordx4 v[140:143], v7, s[52:55], s79 offen nt
    s_add_u32 s79, s79, 7168
    s_mov_b32 s75, 0
L_lw2:
    ds_read_b32 v6, v1 offset:16
    s_waitcnt lgkmcnt(0)
    v_cmp_le_u32 vcc, 5, v6
    s_nop 3
    s_cbranch_vccnz L_lw2_ok
    s_add_u32 s75, s75, 1
    s_sleep 1
    s_cmp_lt_u32 s75, 480000
    s_cbranch_scc1 L_lw2
L_lw2_ok:
    buffer_load_dwordx4 v[144:147], v7, s[52:55], s79 offen nt
    s_add_u32 s79, s79, 7168
    buffer_load_dwordx4 v[148:151], v7, s[52:55], s79 offen nt
    s_add_u32 s79, s79, 7168
    buffer_load_dwordx4 v[152:155], v7, s[52:55], s79 offen nt
    s_add_u32 s79, s79, 7168
    buffer_load_dwordx4 v[156:159], v7, s[52:55], s79 offen nt
    s_add_u32 s79, s79, 7168
    buffer_load_dwordx4 v[160:163], v7, s[52:55], s79 offen nt
    s_add_u32 s79, s79, 7168
    buffer_load_dwordx4 v[164:167], v7, s[52:55], s79 offen nt
    s_add_u32 s79, s79, 7168
    s_branch L_m_join
L_m_ctrl:
    ds_read_b128 v[88:91], v1 offset:96
    ds_read_b128 v[92:95], v1 offset:112
    ds_read_b64 v[96:97], v237 offset:128
    v_cmp_eq_u32 vcc, 4, v0
    v_mov_b32 v234, s94
    v_mov_b32 v235, s95
    s_waitcnt lgkmcnt(0)
    v_max_u32 v232, v88, v89
    v_min_u32 v233, v88, v89
    v_med3_u32 v233, v232, v233, v90
    v_max_u32 v232, v232, v90
    v_med3_u32 v233, v232, v233, v91
    v_max_u32 v232, v232, v91
    v_med3_u32 v233, v232, v233, v92
    v_max_u32 v232, v232, v92
    v_med3_u32 v233, v232, v233, v93
    v_max_u32 v232, v232, v93
    v_med3_u32 v233, v232, v233, v94
    v_max_u32 v232, v232, v94
    v_med3_u32 v233, v232, v233, v95
    v_max_u32 v232, v232, v95
    v_cndmask_b32 v232, v96, v232, vcc
    v_cndmask_b32 v233, v97, v233, vcc
    s_mov_b64 exec, 31
    buffer_store_dwordx4 v[232:235], v236, s[60:63], 0 offen sc1
    s_mov_b64 exec, -1
    s_sleep 40
    s_mov_b32 s75, 0
L_m_gather:
    buffer_load_dwordx2 v[14:15], v1, s[64:67], 0 offen sc1
    buffer_load_dwordx4 v[40:43], v3, s[60:63], 0 offen sc1
    buffer_load_dwordx4 v[44:47], v3, s[60:63], 0 offen offset:1024 sc1
    buffer_load_dwordx4 v[48:51], v3, s[60:63], 0 offen offset:2048 sc1
    buffer_load_dwordx4 v[52:55], v3, s[60:63], 0 offen offset:3072 sc1
    s_waitcnt vmcnt(0)
L_m_gather1:
    v_cmp_ne_u64 vcc, 0, v[14:15]
    s_nop 3
    s_cbranch_vccz L_m_gather_next
    v_cmp_ge_u64 vcc, v[234:235], v[14:15]
    s_nop 3
    s_cbranch_vccnz L_m_gather_chk
    v_mov_b32 v234, v14
    v_mov_b32 v235, v15
    s_mov_b64 exec, 31
    buffer_store_dwordx4 v[232:235], v236, s[60:63], 0 offen sc1
    s_mov_b64 exec, -1
L_m_gather_chk:
    v_add_co_u32 v248, vcc, 0x4000000, v14
    s_nop 1
    v_addc_co_u32 v249, vcc, 0, v15, vcc
    s_mov_b64 s[8:9], exec
    v_cmp_ge_u64 vcc, v[42:43], v[14:15]
    s_nop 0
    s_and_b64 s[8:9], s[8:9], vcc
    v_cmp_lt_u64 vcc, v[42:43], v[248:249]
    s_nop 0
    s_and_b64 s[8:9], s[8:9], vcc
    v_cmp_ge_u64 vcc, v[46:47], v[14:15]
    s_nop 0
    s_and_b64 s[8:9], s[8:9], vcc
    v_cmp_lt_u64 vcc, v[46:47], v[248:249]
    s_nop 0
    s_and_b64 s[8:9], s[8:9], vcc
    v_cmp_ge_u64 vcc, v[50:51], v[14:15]
    s_nop 0
    s_and_b64 s[8:9], s[8:9], vcc
    v_cmp_lt_u64 vcc, v[50:51], v[248:249]
    s_nop 0
    s_and_b64 s[8:9], s[8:9], vcc
    v_cmp_ge_u64 vcc, v[54:55], v[14:15]
    s_nop 0
    s_and_b64 s[8:9], s[8:9], vcc
    v_cmp_lt_u64 vcc, v[54:55], v[248:249]
    s_nop 0
    s_and_b64 s[8:9], s[8:9], vcc
    s_cmp_eq_u64 s[8:9], exec
    s_nop 0
    s_cbranch_scc1 L_m_gather_ok
L_m_gather_next:
    s_add_u32 s75, s75, 1
    s_sleep 2
    s_cmp_lt_u32 s75, 60000
    s_cbranch_scc1 L_m_gather
    v_or_b32 v14, 16, v14
L_m_gather_ok:
    v_max_u32 v88, v40, v41
    v_min_u32 v89, v40, v41
    v_med3_u32 v89, v88, v89, v44
    v_max_u32 v88, v88, v44
    v_med3_u32 v89, v88, v89, v45
    v_max_u32 v88, v88, v45
    v_med3_u32 v89, v88, v89, v48
    v_max_u32 v88, v88, v48
    v_med3_u32 v89, v88, v89, v49
    v_max_u32 v88, v88, v49
    v_med3_u32 v89, v88, v89, v52
    v_max_u32 v88, v88, v52
    v_med3_u32 v89, v88, v89, v53
    v_max_u32 v88, v88, v53
    v_mov_b32 v92, v88
    s_nop 1
    v_max_u32_dpp v92, v92, v92 quad_perm:[1,0,3,2] row_mask:0xf bank_mask:0xf
    s_nop 1
    v_max_u32_dpp v92, v92, v92 quad_perm:[2,3,0,1] row_mask:0xf bank_mask:0xf
    s_nop 1
    v_max_u32_dpp v92, v92, v92 row_half_mirror row_mask:0xf bank_mask:0xf
    s_nop 1
    v_max_u32_dpp v92, v92, v92 row_mirror row_mask:0xf bank_mask:0xf
    v_mov_b32 v94, v92
    s_nop 1
    v_permlane16_swap_b32 v94, v92
    v_max_u32 v92, v92, v94
    v_mov_b32 v94, v92
    s_nop 1
    v_permlane32_swap_b32 v94, v92
    v_max_u32 v92, v92, v94
    v_cmp_eq_u32 vcc, v88, v92
    s_nop 1
    v_cndmask_b32 v93, v88, v89, vcc
    s_nop 1
    v_max_u32_dpp v93, v93, v93 quad_perm:[1,0,3,2] row_mask:0xf bank_mask:0xf
    s_nop 1
    v_max_u32_dpp v93, v93, v93 quad_perm:[2,3,0,1] row_mask:0xf bank_mask:0xf
    s_nop 1
    v_max_u32_dpp v93, v93, v93 row_half_mirror row_mask:0xf bank_mask:0xf
    s_nop 1
    v_max_u32_dpp v93, v93, v93 row_mirror row_mask:0xf bank_mask:0xf
    v_mov_b32 v94, v93
    s_nop 1
    v_permlane16_swap_b32 v94, v93
    v_max_u32 v93, v93, v94
    v_mov_b32 v94, v93
    s_nop 1
    v_permlane32_swap_b32 v94, v93
    v_max_u32 v93, v93, v94
    v_cmp_le_u32 vcc, 32, v0
    s_nop 1
    v_cndmask_b32 v88, v92, v93, vcc
    v_and_b32 v88, 0x7ff, v88
    v_sub_u32 v88, 2047, v88
    v_and_b32 v5, 31, v0
    v_lshlrev_b32 v5, 4, v5
    v_lshl_add_u32 v5, v88, 11, v5
    s_lshl_b32 s7, s72, 9
    buffer_load_dwordx4 v[40:43], v5, s[44:47], s7 offen
    v_lshrrev_b32 v6, 1, v88
    v_lshlrev_b32 v6, 4, v6
    s_mov_b32 s7, 8192
    buffer_load_dwordx4 v[44:47], v6, s[60:63], s7 offen sc1
    v_mov_b32 v94, v14
    v_mov_b32 v95, v15
    s_mov_b64 exec, 1
    ds_write_b128 v1, v[92:95] offset:64
    ds_add_u32 v1, v13 offset:16
    s_mov_b64 exec, -1
    s_mov_b32 s75, 0
L_lw3:
    ds_read_b32 v96, v1 offset:16
    s_waitcnt lgkmcnt(0)
    v_cmp_le_u32 vcc, 5, v96
    s_nop 3
    s_cbranch_vccnz L_lw3_ok
    s_add_u32 s75, s75, 1
    s_sleep 1
    s_cmp_lt_u32 s75, 480000
    s_cbranch_scc1 L_lw3
L_lw3_ok:
    buffer_load_dwordx4 v[104:107], v7, s[52:55], s79 offen nt
    s_add_u32 s79, s79, 7168
    buffer_load_dwordx4 v[108:111], v7, s[52:55], s79 offen nt
    s_add_u32 s79, s79, 7168
    buffer_load_dwordx4 v[112:115], v7, s[52:55], s79 offen nt
    s_add_u32 s79, s79, 7168
    buffer_load_dwordx4 v[116:119], v7, s[52:55], s79 offen nt
    s_add_u32 s79, s79, 7168
    buffer_load_dwordx4 v[120:123], v7, s[52:55], s79 offen nt
    s_add_u32 s79, s79, 7168
    buffer_load_dwordx4 v[124:127], v7, s[52:55], s79 offen nt
    s_add_u32 s79, s79, 7168
    s_waitcnt vmcnt(6)
    s_mov_b32 s75, 0
L_m_xstat:
    s_mov_b64 s[8:9], exec
    v_cmp_ge_u64 vcc, v[46:47], v[14:15]
    s_nop 0
    s_and_b64 s[8:9], s[8:9], vcc
    v_cmp_lt_u64 vcc, v[46:47], v[248:249]
    s_nop 0
    s_and_b64 s[8:9], s[8:9], vcc
    s_cmp_eq_u64 s[8:9], exec
    s_nop 0
    s_cbranch_scc1 L_m_xstat_ok
    s_sleep 4
    buffer_load_dwordx4 v[44:47], v6, s[60:63], s7 offen sc1
    s_add_u32 s75, s75, 1
    s_waitcnt vmcnt(0)
    s_cmp_lt_u32 s75, 60000
    s_cbranch_scc1 L_m_xstat
L_m_xstat_ok:
    v_and_b32 v5, 1, v88
    v_cmp_eq_u32 vcc, 1, v5
    s_nop 1
    v_cndmask_b32 v5, v44, v45, vcc
    v_and_b32 v89, 0xffff0000, v5
    v_lshlrev_b32 v90, 16, v5
    v_rcp_f32 v90, v90
    v_lshlrev_b32 v48, 16, v40
    v_and_b32 v49, 0xffff0000, v40
    v_lshlrev_b32 v50, 16, v41
    v_and_b32 v51, 0xffff0000, v41
    v_lshlrev_b32 v52, 16, v42
    v_and_b32 v53, 0xffff0000, v42
    v_lshlrev_b32 v54, 16, v43
    v_and_b32 v55, 0xffff0000, v43
    v_sub_f32 v48, v48, v89
    v_sub_f32 v49, v49, v89
    v_sub_f32 v50, v50, v89
    v_sub_f32 v51, v51, v89
    v_sub_f32 v52, v52, v89
    v_sub_f32 v53, v53, v89
    v_sub_f32 v54, v54, v89
    v_sub_f32 v55, v55, v89
    v_cvt_pk_bf16_f32 v40, v48, v49
    v_lshlrev_b32 v48, 16, v40
    v_and_b32 v49, 0xffff0000, v40
    v_cvt_pk_bf16_f32 v41, v50, v51
    v_lshlrev_b32 v50, 16, v41
    v_and_b32 v51, 0xffff0000, v41
    v_cvt_pk_bf16_f32 v42, v52, v53
    v_lshlrev_b32 v52, 16, v42
    v_and_b32 v53, 0xffff0000, v42
    v_cvt_pk_bf16_f32 v43, v54, v55
    v_lshlrev_b32 v54, 16, v43
    v_and_b32 v55, 0xffff0000, v43
    v_mul_f32 v48, v48, v90
    v_mul_f32 v49, v49, v90
    v_mul_f32 v50, v50, v90
    v_mul_f32 v51, v51, v90
    v_mul_f32 v52, v52, v90
    v_mul_f32 v53, v53, v90
    v_mul_f32 v54, v54, v90
    v_mul_f32 v55, v55, v90
    v_cvt_pk_bf16_f32 v48, v48, v48
    v_cvt_pk_bf16_f32 v49, v49, v49
    v_cvt_pk_bf16_f32 v50, v50, v50
    v_cvt_pk_bf16_f32 v51, v51, v51
    v_cvt_pk_bf16_f32 v52, v52, v52
    v_cvt_pk_bf16_f32 v53, v53, v53
    v_cvt_pk_bf16_f32 v54, v54, v54
    v_cvt_pk_bf16_f32 v55, v55, v55
    v_lshlrev_b32 v5, 5, v0
    ds_write_b128 v5, v[48:51] offset:9472
    ds_write_b128 v5, v[52:55] offset:9488
    s_mov_b64 exec, 1
    ds_add_u32 v1, v13 offset:12
    s_mov_b64 exec, -1
    buffer_load_dwordx4 v[128:131], v7, s[52:55], s79 offen nt
    s_add_u32 s79, s79, 7168
    buffer_load_dwordx4 v[132:135], v7, s[52:55], s79 offen nt
    s_add_u32 s79, s79, 7168
    buffer_load_dwordx4 v[136:139], v7, s[52:55], s79 offen nt
    s_add_u32 s79, s79, 7168
    buffer_load_dwordx4 v[140:143], v7, s[52:55], s79 offen nt
    s_add_u32 s79, s79, 7168
    buffer_load_dwordx4 v[144:147], v7, s[52:55], s79 offen nt
    s_add_u32 s79, s79, 7168
    buffer_load_dwordx4 v[148:151], v7, s[52:55], s79 offen nt
    s_add_u32 s79, s79, 7168
    buffer_load_dwordx4 v[152:155], v7, s[52:55], s79 offen nt
    s_add_u32 s79, s79, 7168
    buffer_load_dwordx4 v[156:159], v7, s[52:55], s79 offen nt
    s_add_u32 s79, s79, 7168
    buffer_load_dwordx4 v[160:163], v7, s[52:55], s79 offen nt
    s_add_u32 s79, s79, 7168
    buffer_load_dwordx4 v[164:167], v7, s[52:55], s79 offen nt
    s_add_u32 s79, s79, 7168
L_m_join:
    s_mov_b32 s75, 0
L_lw4:
    ds_read_b32 v6, v1 offset:12
    s_waitcnt lgkmcnt(0)
    v_cmp_le_u32 vcc, 1, v6
    s_nop 3
    s_cbranch_vccnz L_lw4_ok
    s_add_u32 s75, s75, 1
    s_sleep 1
    s_cmp_lt_u32 s75, 480000
    s_cbranch_scc1 L_lw4
L_lw4_ok:
    s_setprio 2
    ds_read_b128 v[88:91], v1 offset:64
    v_lshrrev_b32 v5, 3, v9
    v_lshlrev_b32 v5, 10, v5
    v_lshl_add_u32 v5, v10, 6, v5
    s_lshl_b32 s7, s3, 8
    v_add_u32 v5, s7, v5
    ds_read_b128 v[216:219], v5 offset:9472
    ds_read_b128 v[220:223], v5 offset:9488
    ds_read_b128 v[224:227], v5 offset:9504
    ds_read_b128 v[228:231], v5 offset:9520
    s_waitcnt lgkmcnt(0)
    v_mov_b32 v14, v90
    v_mov_b32 v15, v91
    v_readfirstlane_b32 s76, v88
    v_readfirstlane_b32 s77, v89
    v_add_co_u32 v248, vcc, 0x4000000, v14
    s_nop 1
    v_addc_co_u32 v249, vcc, 0, v15, vcc
    v_mov_b32 v234, v14
    v_mov_b32 v235, v15
    v_mov_b32 v238, v14
    v_mov_b32 v239, v15
    s_lshl_b32 s7, s73, 2
    s_add_u32 s7, s7, s72
    s_mul_i32 s7, s7, 3584
    s_lshl_b32 s8, s74, 7
    s_add_u32 s7, s7, s8
    s_lshl_b32 s7, s7, 3
    s_add_u32 s7, s7, 65536
    v_lshlrev_b32 v5, 3, v0
    v_and_b32 v200, v196, v216
    v_and_b32 v201, v197, v216
    v_and_b32 v202, v198, v216
    v_and_b32 v203, v199, v216
    s_waitcnt vmcnt(15)
    s_nop 0
    v_mfma_f32_16x16x32_bf16 v[208:211], v[104:107], v[200:203], 0
    v_and_b32 v204, v196, v217
    v_and_b32 v205, v197, v217
    v_and_b32 v206, v198, v217
    v_and_b32 v207, v199, v217
    s_waitcnt vmcnt(14)
    s_nop 0
    v_mfma_f32_16x16x32_bf16 v[208:211], v[108:111], v[204:207], v[208:211]
    v_and_b32 v200, v196, v218
    v_and_b32 v201, v197, v218
    v_and_b32 v202, v198, v218
    v_and_b32 v203, v199, v218
    s_waitcnt vmcnt(13)
    s_nop 0
    v_mfma_f32_16x16x32_bf16 v[208:211], v[112:115], v[200:203], v[208:211]
    v_and_b32 v204, v196, v219
    v_and_b32 v205, v197, v219
    v_and_b32 v206, v198, v219
    v_and_b32 v207, v199, v219
    s_waitcnt vmcnt(12)
    s_nop 0
    v_mfma_f32_16x16x32_bf16 v[208:211], v[116:119], v[204:207], v[208:211]
    v_and_b32 v200, v196, v220
    v_and_b32 v201, v197, v220
    v_and_b32 v202, v198, v220
    v_and_b32 v203, v199, v220
    s_waitcnt vmcnt(11)
    s_nop 0
    v_mfma_f32_16x16x32_bf16 v[208:211], v[120:123], v[200:203], v[208:211]
    v_and_b32 v204, v196, v221
    v_and_b32 v205, v197, v221
    v_and_b32 v206, v198, v221
    v_and_b32 v207, v199, v221
    s_waitcnt vmcnt(10)
    s_nop 0
    v_mfma_f32_16x16x32_bf16 v[208:211], v[124:127], v[204:207], v[208:211]
    v_and_b32 v200, v196, v222
    v_and_b32 v201, v197, v222
    v_and_b32 v202, v198, v222
    v_and_b32 v203, v199, v222
    s_waitcnt vmcnt(9)
    s_nop 0
    v_mfma_f32_16x16x32_bf16 v[208:211], v[128:131], v[200:203], v[208:211]
    v_and_b32 v204, v196, v223
    v_and_b32 v205, v197, v223
    v_and_b32 v206, v198, v223
    v_and_b32 v207, v199, v223
    s_waitcnt vmcnt(8)
    s_nop 0
    v_mfma_f32_16x16x32_bf16 v[208:211], v[132:135], v[204:207], v[208:211]
    v_and_b32 v200, v196, v224
    v_and_b32 v201, v197, v224
    v_and_b32 v202, v198, v224
    v_and_b32 v203, v199, v224
    s_waitcnt vmcnt(7)
    s_nop 0
    v_mfma_f32_16x16x32_bf16 v[208:211], v[136:139], v[200:203], v[208:211]
    v_and_b32 v204, v196, v225
    v_and_b32 v205, v197, v225
    v_and_b32 v206, v198, v225
    v_and_b32 v207, v199, v225
    s_waitcnt vmcnt(6)
    s_nop 0
    v_mfma_f32_16x16x32_bf16 v[208:211], v[140:143], v[204:207], v[208:211]
    v_and_b32 v200, v196, v226
    v_and_b32 v201, v197, v226
    v_and_b32 v202, v198, v226
    v_and_b32 v203, v199, v226
    s_waitcnt vmcnt(5)
    s_nop 0
    v_mfma_f32_16x16x32_bf16 v[208:211], v[144:147], v[200:203], v[208:211]
    v_and_b32 v204, v196, v227
    v_and_b32 v205, v197, v227
    v_and_b32 v206, v198, v227
    v_and_b32 v207, v199, v227
    s_waitcnt vmcnt(4)
    s_nop 0
    v_mfma_f32_16x16x32_bf16 v[208:211], v[148:151], v[204:207], v[208:211]
    v_and_b32 v200, v196, v228
    v_and_b32 v201, v197, v228
    v_and_b32 v202, v198, v228
    v_and_b32 v203, v199, v228
    s_waitcnt vmcnt(3)
    s_nop 0
    v_mfma_f32_16x16x32_bf16 v[208:211], v[152:155], v[200:203], v[208:211]
    v_and_b32 v204, v196, v229
    v_and_b32 v205, v197, v229
    v_and_b32 v206, v198, v229
    v_and_b32 v207, v199, v229
    s_waitcnt vmcnt(2)
    s_nop 0
    v_mfma_f32_16x16x32_bf16 v[208:211], v[156:159], v[204:207], v[208:211]
    v_and_b32 v200, v196, v230
    v_and_b32 v201, v197, v230
    v_and_b32 v202, v198, v230
    v_and_b32 v203, v199, v230
    s_waitcnt vmcnt(1)
    s_nop 0
    v_mfma_f32_16x16x32_bf16 v[208:211], v[160:163], v[200:203], v[208:211]
    v_and_b32 v204, v196, v231
    v_and_b32 v205, v197, v231
    v_and_b32 v206, v198, v231
    v_and_b32 v207, v199, v231
    s_waitcnt vmcnt(0)
    s_nop 0
    v_mfma_f32_16x16x32_bf16 v[208:211], v[164:167], v[204:207], v[208:211]
    s_cmp_ge_u32 s93, 224
    s_nop 5
    s_cbranch_scc1 L_m_noG
    ds_write_b32 v240, v208 offset:256
    ds_write_b32 v240, v209 offset:320
    ds_write_b32 v240, v210 offset:384
    ds_write_b32 v240, v211 offset:448
    s_mov_b64 exec, 1
    ds_add_rtn_u32 v90, v1, v13 offset:4
    s_mov_b64 exec, -1
    ds_read_b128 v[40:43], v3 offset:256
    ds_read_b128 v[44:47], v3 offset:1280
    ds_read_b128 v[48:51], v3 offset:2304
    ds_read_b128 v[52:55], v3 offset:3328
    s_waitcnt lgkmcnt(0)
    v_readfirstlane_b32 s78, v90
    v_add_f32 v40, v40, v44
    v_add_f32 v41, v41, v45
    v_add_f32 v48, v48, v52
    v_add_f32 v49, v49, v53
    v_add_f32 v42, v42, v46
    v_add_f32 v43, v43, v47
    v_add_f32 v50, v50, v54
    v_add_f32 v51, v51, v55
    s_cmp_eq_u32 s78, 3
    s_cbranch_scc0 L_m_gwait
    v_add_f32 v40, v40, v48
    v_add_f32 v41, v41, v49
    v_add_f32 v42, v42, v50
    v_add_f32 v43, v43, v51
    v_cvt_pk_bf16_f32 v232, v40, v41
    v_cvt_pk_bf16_f32 v233, v42, v43
    buffer_store_dwordx4 v[232:235], v3, s[60:63], s7 offen sc1
    s_mov_b64 exec, 1
    ds_add_u32 v1, v13 offset:4
    s_mov_b64 exec, -1
L_m_gwait:
    s_setprio 0
    buffer_load_dwordx2 v[16:17], v2, s[44:47], 0 offen
    buffer_load_dwordx2 v[18:19], v2, s[44:47], 0 offen offset:2048
    buffer_load_dwordx2 v[20:21], v2, s[44:47], s84 offen
    buffer_load_dwordx2 v[22:23], v2, s[44:47], s84 offen offset:2048
    buffer_load_dwordx2 v[24:25], v2, s[44:47], s85 offen
    buffer_load_dwordx2 v[26:27], v2, s[44:47], s85 offen offset:2048
    buffer_load_dwordx2 v[28:29], v2, s[44:47], s86 offen
    buffer_load_dwordx2 v[30:31], v2, s[44:47], s86 offen offset:2048
    buffer_load_dwordx4 v[72:75], v11, s[60:63], s15 offen sc1
    buffer_load_dwordx4 v[76:79], v11, s[60:63], s15 offen offset:16 sc1
    buffer_load_dwordx4 v[80:83], v11, s[60:63], s15 offen offset:32 sc1
    buffer_load_dwordx4 v[84:87], v11, s[60:63], s15 offen offset:48 sc1
    s_mov_b32 s75, 0
L_lw5:
    ds_read_b32 v6, v1 offset:4
    s_waitcnt lgkmcnt(0)
    v_cmp_le_u32 vcc, 5, v6
    s_nop 3
    s_cbranch_vccnz L_lw5_ok
    s_add_u32 s75, s75, 1
    s_sleep 1
    s_cmp_lt_u32 s75, 480000
    s_cbranch_scc1 L_lw5
L_lw5_ok:
    s_branch L_m_rest
L_m_noG:
    s_setprio 0
    buffer_load_dwordx2 v[16:17], v2, s[44:47], 0 offen
    buffer_load_dwordx2 v[18:19], v2, s[44:47], 0 offen offset:2048
    buffer_load_dwordx2 v[20:21], v2, s[44:47], s84 offen
    buffer_load_dwordx2 v[22:23], v2, s[44:47], s84 offen offset:2048
    buffer_load_dwordx2 v[24:25], v2, s[44:47], s85 offen
    buffer_load_dwordx2 v[26:27], v2, s[44:47], s85 offen offset:2048
    buffer_load_dwordx2 v[28:29], v2, s[44:47], s86 offen
    buffer_load_dwordx2 v[30:31], v2, s[44:47], s86 offen offset:2048
    buffer_load_dwordx4 v[72:75], v11, s[60:63], s15 offen sc1
    buffer_load_dwordx4 v[76:79], v11, s[60:63], s15 offen offset:16 sc1
    buffer_load_dwordx4 v[80:83], v11, s[60:63], s15 offen offset:32 sc1
    buffer_load_dwordx4 v[84:87], v11, s[60:63], s15 offen offset:48 sc1
L_m_rest:
    buffer_load_dwordx4 v[168:171], v8, s[56:59], s92 offen nt
    s_add_u32 s92, s92, 8192
    buffer_load_dwordx4 v[172:175], v8, s[56:59], s92 offen nt
    s_add_u32 s92, s92, 8192
    buffer_load_dwordx4 v[176:179], v8, s[56:59], s92 offen nt
    s_add_u32 s92, s92, 8192
    buffer_load_dwordx4 v[180:183], v8, s[56:59], s92 offen nt
    s_add_u32 s92, s92, 8192
    buffer_load_dwordx4 v[184:187], v8, s[56:59], s92 offen nt
    s_add_u32 s92, s92, 8192
    buffer_load_dwordx4 v[188:191], v8, s[56:59], s92 offen nt
    s_add_u32 s92, s92, 8192
    buffer_load_dwordx4 v[192:195], v8, s[56:59], s92 offen nt
    s_add_u32 s92, s92, 8192
    buffer_load_dword v250, v244, s[60:63], s12 offen sc1
    s_sleep 8
    buffer_load_dwordx4 v[40:43], v245, s[60:63], s80 offen sc1
    buffer_load_dwordx4 v[44:47], v245, s[60:63], s81 offen sc1
    buffer_load_dwordx4 v[48:51], v245, s[60:63], s82 offen sc1
    buffer_load_dwordx4 v[52:55], v245, s[60:63], s83 offen sc1
    s_waitcnt vmcnt(12)
    s_mov_b32 s75, 0
L_m_stat:
    s_mov_b64 s[8:9], exec
    v_cmp_ge_u64 vcc, v[74:75], v[14:15]
    s_nop 0
    s_and_b64 s[8:9], s[8:9], vcc
    v_cmp_lt_u64 vcc, v[74:75], v[248:249]
    s_nop 0
    s_and_b64 s[8:9], s[8:9], vcc
    v_cmp_ge_u64 vcc, v[78:79], v[14:15]
    s_nop 0
    s_and_b64 s[8:9], s[8:9], vcc
    v_cmp_lt_u64 vcc, v[78:79], v[248:249]
    s_nop 0
    s_and_b64 s[8:9], s[8:9], vcc
    v_cmp_ge_u64 vcc, v[82:83], v[14:15]
    s_nop 0
    s_and_b64 s[8:9], s[8:9], vcc
    v_cmp_lt_u64 vcc, v[82:83], v[248:249]
    s_nop 0
    s_and_b64 s[8:9], s[8:9], vcc
    v_cmp_ge_u64 vcc, v[86:87], v[14:15]
    s_nop 0
    s_and_b64 s[8:9], s[8:9], vcc
    v_cmp_lt_u64 vcc, v[86:87], v[248:249]
    s_nop 0
    s_and_b64 s[8:9], s[8:9], vcc
    s_cmp_eq_u64 s[8:9], exec
    s_nop 0
    s_cbranch_scc1 L_m_stat_ok
    s_sleep 4
    buffer_load_dwordx4 v[72:75], v11, s[60:63], s15 offen sc1
    buffer_load_dwordx4 v[76:79], v11, s[60:63], s15 offen offset:16 sc1
    buffer_load_dwordx4 v[80:83], v11, s[60:63], s15 offen offset:32 sc1
    buffer_load_dwordx4 v[84:87], v11, s[60:63], s15 offen offset:48 sc1
    s_add_u32 s75, s75, 1
    s_waitcnt vmcnt(0)
    s_cmp_lt_u32 s75, 60000
    s_cbranch_scc1 L_m_stat
L_m_stat_ok:
    s_mul_i32 s10, s3, 6144
    v_add_u32 v6, s10, v3
    ds_write_b128 v6, v[16:19] offset:11520
    ds_write_b128 v6, v[20:23] offset:12544
    ds_write_b128 v6, v[24:27] offset:13568
    ds_write_b128 v6, v[28:31] offset:14592
    v_add_u32 v6, s10, v5
    ds_write_b64 v6, v[72:73] offset:15616
    ds_write_b64 v6, v[76:77] offset:16128
    ds_write_b64 v6, v[80:81] offset:16640
    ds_write_b64 v6, v[84:85] offset:17152
    s_lshl_b32 s10, s3, 2
    v_mov_b32 v6, s10
    s_mov_b64 exec, 1
    ds_add_u32 v6, v13 offset:32
    s_mov_b64 exec, -1
    s_mov_b32 s75, 0
L_lw6:
    ds_read_b32 v6, v1 offset:28
    s_waitcnt lgkmcnt(0)
    v_cmp_le_u32 vcc, 1, v6
    s_nop 3
    s_cbranch_vccnz L_lw6_ok
    s_add_u32 s75, s75, 1
    s_sleep 1
    s_cmp_lt_u32 s75, 480000
    s_cbranch_scc1 L_lw6
L_lw6_ok:
    v_readfirstlane_b32 s14, v6
    s_mov_b32 s75, 0
    s_mov_b64 s[92:93], -1
    s_mov_b64 s[94:95], -1
    s_mov_b64 s[96:97], -1
    s_mov_b64 s[98:99], -1
    s_branch L_m_pre1
L_m_pre:
    s_mov_b64 exec, s[92:93]
    s_cbranch_execz L_m_pre_s0
    buffer_load_dwordx4 v[40:43], v245, s[60:63], s80 offen sc1
L_m_pre_s0:
    s_mov_b64 exec, s[94:95]
    s_cbranch_execz L_m_pre_s1
    buffer_load_dwordx4 v[44:47], v245, s[60:63], s81 offen sc1
L_m_pre_s1:
    s_mov_b64 exec, s[96:97]
    s_cbranch_execz L_m_pre_s2
    buffer_load_dwordx4 v[48:51], v245, s[60:63], s82 offen sc1
L_m_pre_s2:
    s_mov_b64 exec, s[98:99]
    s_cbranch_execz L_m_pre_s3
    buffer_load_dwordx4 v[52:55], v245, s[60:63], s83 offen sc1
L_m_pre_s3:
    s_mov_b64 exec, -1
L_m_pre1:
    s_waitcnt vmcnt(0)
    v_cmp_ne_u64 s[92:93], v[42:43], v[14:15]
    v_cmp_ne_u64 s[94:95], v[46:47], v[14:15]
    v_cmp_ne_u64 s[96:97], v[50:51], v[14:15]
    v_cmp_ne_u64 s[98:99], v[54:55], v[14:15]
    s_or_b64 s[10:11], s[92:93], s[94:95]
    s_or_b64 s[10:11], s[10:11], s[96:97]
    s_or_b64 s[10:11], s[10:11], s[98:99]
    s_nop 0
    s_cbranch_scc0 L_m_pre_ok
    s_add_u32 s75, s75, 1
    s_sleep 8
    s_cmp_lt_u32 s75, 60000
    s_cbranch_scc1 L_m_pre
L_m_pre_ok:
    s_setprio 2
    v_cmp_eq_u32 vcc, 1, v246
    s_nop 1
    v_cndmask_b32 v42, v40, v41, vcc
    v_cndmask_b32 v46, v44, v45, vcc
    v_cndmask_b32 v50, v48, v49, vcc
    v_cndmask_b32 v54, v52, v53, vcc
    v_lshlrev_b32 v40, 16, v42
    v_and_b32 v41, 0xffff0000, v42
    v_lshlrev_b32 v44, 16, v46
    v_and_b32 v45, 0xffff0000, v46
    v_lshlrev_b32 v48, 16, v50
    v_and_b32 v49, 0xffff0000, v50
    v_lshlrev_b32 v52, 16, v54
    v_and_b32 v53, 0xffff0000, v54
    v_add_f32 v40, v40, v44
    v_add_f32 v41, v41, v45
    v_add_f32 v48, v48, v52
    v_add_f32 v49, v49, v53
    v_add_f32 v40, v40, v48
    v_add_f32 v41, v41, v49
    v_cvt_pk_bf16_f32 v44, v40, v41
    v_lshlrev_b32 v40, 16, v44
    v_and_b32 v41, 0xffff0000, v44
    v_mul_f32 v44, 0xbfb8aa3b, v40
    v_mul_f32 v45, 0xbfb8aa3b, v41
    v_exp_f32 v44, v44
    v_exp_f32 v45, v45
    v_add_f32 v44, 1.0, v44
    v_add_f32 v45, 1.0, v45
    v_rcp_f32 v44, v44
    v_rcp_f32 v45, v45
    v_mul_f32 v44, v44, v40
    v_mul_f32 v45, v45, v41
    v_cvt_pk_bf16_f32 v46, v44, v45
    v_lshlrev_b32 v44, 16, v46
    v_and_b32 v45, 0xffff0000, v46
    s_nop 0
    v_mul_f32_dpp v48, v40, v44 quad_perm:[1,0,3,2] row_mask:0xf bank_mask:0xf
    v_mul_f32_dpp v49, v41, v45 quad_perm:[1,0,3,2] row_mask:0xf bank_mask:0xf
    s_mov_b32 s8, 0x55555555
    s_mov_b32 s9, 0x55555555
    v_cvt_pk_bf16_f32 v48, v48, v48
    v_cvt_pk_bf16_f32 v49, v49, v49
    s_mov_b64 exec, s[8:9]
    ds_write_b32 v242, v48 offset:8448
    ds_write_b32 v242, v49 offset:8576
    s_mov_b64 exec, -1
    ds_read_b128 v[216:219], v243 offset:8448
    ds_read_b128 v[220:223], v243 offset:8464
    s_waitcnt lgkmcnt(0)
    v_and_b32 v200, v196, v216
    v_and_b32 v201, v197, v216
    v_and_b32 v202, v198, v216
    v_and_b32 v203, v199, v216
    s_nop 1
    v_mfma_f32_16x16x32_bf16 v[208:211], v[168:171], v[200:203], 0
    v_and_b32 v204, v196, v217
    v_and_b32 v205, v197, v217
    v_and_b32 v206, v198, v217
    v_and_b32 v207, v199, v217
    s_nop 1
    v_mfma_f32_16x16x32_bf16 v[208:211], v[172:175], v[204:207], v[208:211]
    v_and_b32 v200, v196, v218
    v_and_b32 v201, v197, v218
    v_and_b32 v202, v198, v218
    v_and_b32 v203, v199, v218
    s_nop 1
    v_mfma_f32_16x16x32_bf16 v[208:211], v[176:179], v[200:203], v[208:211]
    v_and_b32 v204, v196, v219
    v_and_b32 v205, v197, v219
    v_and_b32 v206, v198, v219
    v_and_b32 v207, v199, v219
    s_nop 1
    v_mfma_f32_16x16x32_bf16 v[208:211], v[180:183], v[204:207], v[208:211]
    v_and_b32 v200, v196, v220
    v_and_b32 v201, v197, v220
    v_and_b32 v202, v198, v220
    v_and_b32 v203, v199, v220
    s_nop 1
    v_mfma_f32_16x16x32_bf16 v[208:211], v[184:187], v[200:203], v[208:211]
    v_and_b32 v204, v196, v221
    v_and_b32 v205, v197, v221
    v_and_b32 v206, v198, v221
    v_and_b32 v207, v199, v221
    s_nop 1
    v_mfma_f32_16x16x32_bf16 v[208:211], v[188:191], v[204:207], v[208:211]
    v_and_b32 v200, v196, v222
    v_and_b32 v201, v197, v222
    v_and_b32 v202, v198, v222
    v_and_b32 v203, v199, v222
    s_nop 1
    v_mfma_f32_16x16x32_bf16 v[208:211], v[192:195], v[200:203], v[208:211]
    s_nop 7
    ds_write_b32 v241, v208 offset:4352
    ds_write_b32 v241, v209 offset:4384
    ds_write_b32 v241, v210 offset:4416
    ds_write_b32 v241, v211 offset:4448
    s_mov_b64 exec, 1
    ds_add_rtn_u32 v90, v1, v13 offset:8
    s_waitcnt lgkmcnt(0)
    s_mov_b64 exec, -1
    v_readfirstlane_b32 s78, v90
    s_nop 0
    s_cmp_eq_u32 s78, 3
    s_nop 1
    s_cbranch_scc0 L_m_noDpub
    ds_read_b64 v[40:41], v5 offset:4352
    ds_read_b64 v[42:43], v5 offset:5376
    ds_read_b64 v[44:45], v5 offset:6400
    ds_read_b64 v[46:47], v5 offset:7424
    ds_read_b64 v[48:49], v5 offset:4864
    ds_read_b64 v[50:51], v5 offset:5888
    ds_read_b64 v[52:53], v5 offset:6912
    ds_read_b64 v[54:55], v5 offset:7936
    s_waitcnt lgkmcnt(0)
    v_add_f32 v40, v40, v42
    v_add_f32 v41, v41, v43
    v_add_f32 v44, v44, v46
    v_add_f32 v45, v45, v47
    v_add_f32 v48, v48, v50
    v_add_f32 v49, v49, v51
    v_add_f32 v52, v52, v54
    v_add_f32 v53, v53, v55
    v_add_f32 v232, v40, v44
    v_add_f32 v233, v41, v45
    v_add_f32 v236, v48, v52
    v_add_f32 v237, v49, v53
    s_cmp_eq_u32 s14, 2
    s_cbranch_scc0 L_m_dpslow
    buffer_store_dwordx4 v[232:235], v3, s[60:63], s12 offen
    buffer_store_dwordx4 v[236:239], v3, s[60:63], s13 offen
    s_nop 0
    s_branch L_m_noDpub
L_m_dpslow:
    buffer_store_dwordx4 v[232:235], v3, s[60:63], s12 offen sc1
    buffer_store_dwordx4 v[236:239], v3, s[60:63], s13 offen sc1
L_m_noDpub:
    s_and_b32 s15, s76, 0x7ff
    s_sub_u32 s15, 2047, s15
    s_lshr_b32 s7, s15, 6
    s_cmp_eq_u32 s7, s5
    s_cbranch_scc0 L_m_upd_skip0
    s_lshl_b32 s7, s4, 16
    s_add_u32 s7, s7, 524288
    s_lshl_b32 s8, s3, 8
    s_add_u32 s7, s7, s8
    s_add_u32 s8, s7, 4096
    v_lshlrev_b32 v6, 13, v10
    v_lshl_add_u32 v6, v9, 4, v6
    s_mov_b64 s[44:45], -1
    s_mov_b64 s[46:47], -1
    s_mov_b64 s[48:49], -1
    s_mov_b64 s[50:51], -1
    s_mov_b64 s[52:53], -1
    s_mov_b64 s[54:55], -1
    s_mov_b64 s[56:57], -1
    s_mov_b64 s[58:59], -1
    s_and_b32 s9, s76, 0xffff0000
    s_ashr_i32 s10, s9, 31
    s_not_b32 s10, s10
    s_or_b32 s10, s10, 0x80000000
    s_xor_b32 s9, s9, s10
    s_and_b32 s9, s9, 0xffff0000
    v_mov_b32 v88, s9
    v_mul_f32 v88, 0xbfb8aa3b, v88
    v_exp_f32 v88, v88
    s_nop 0
    v_add_f32 v88, 1.0, v88
    v_rcp_f32 v88, v88
    s_nop 0
    v_cvt_pk_bf16_f32 v88, v88, v88
    v_and_b32 v88, 0xffff0000, v88
    s_bfe_u32 s9, s15, 0x10005
    s_lshl_b32 s9, s9, 1
    s_lshr_b32 s10, s3, 1
    s_add_u32 s9, s9, s10
    s_lshl_b32 s10, s9, 2
    v_mov_b32 v89, s10
    s_mul_i32 s9, s9, 16640
    s_and_b32 s10, s15, 31
    s_lshl_b32 s10, s10, 8
    s_add_u32 s9, s9, s10
    s_and_b32 s10, s3, 1
    s_lshl_b32 s10, s10, 7
    s_add_u32 s9, s9, s10
    s_add_u32 s9, s9, 54528
    v_lshlrev_b32 v92, 3, v9
    v_add_u32 v92, s9, v92
    s_lshl_b32 s15, s15, 11
    s_lshl_b32 s9, s4, 8
    s_add_u32 s15, s15, s9
    s_lshl_b32 s9, s3, 6
    s_add_u32 s15, s15, s9
    v_lshlrev_b32 v93, 2, v9
    s_mov_b32 s75, 0
L_m_dp0:
    s_mov_b64 exec, s[44:45]
    s_cbranch_execz L_m_dp0_s0
    buffer_load_dwordx4 v[40:43], v6, s[60:63], s7 offen sc1
L_m_dp0_s0:
    s_mov_b64 exec, s[46:47]
    s_cbranch_execz L_m_dp0_s1
    buffer_load_dwordx4 v[44:47], v6, s[60:63], s7 offen offset:1024 sc1
L_m_dp0_s1:
    s_mov_b64 exec, s[48:49]
    s_cbranch_execz L_m_dp0_s2
    buffer_load_dwordx4 v[48:51], v6, s[60:63], s7 offen offset:2048 sc1
L_m_dp0_s2:
    s_mov_b64 exec, s[50:51]
    s_cbranch_execz L_m_dp0_s3
    buffer_load_dwordx4 v[52:55], v6, s[60:63], s7 offen offset:3072 sc1
L_m_dp0_s3:
    s_mov_b64 exec, s[52:53]
    s_cbranch_execz L_m_dp0_s4
    buffer_load_dwordx4 v[56:59], v6, s[60:63], s8 offen sc1
L_m_dp0_s4:
    s_mov_b64 exec, s[54:55]
    s_cbranch_execz L_m_dp0_s5
    buffer_load_dwordx4 v[60:63], v6, s[60:63], s8 offen offset:1024 sc1
L_m_dp0_s5:
    s_mov_b64 exec, s[56:57]
    s_cbranch_execz L_m_dp0_s6
    buffer_load_dwordx4 v[64:67], v6, s[60:63], s8 offen offset:2048 sc1
L_m_dp0_s6:
    s_mov_b64 exec, s[58:59]
    s_cbranch_execz L_m_dp0_s7
    buffer_load_dwordx4 v[68:71], v6, s[60:63], s8 offen offset:3072 sc1
L_m_dp0_s7:
    s_mov_b64 exec, -1
    s_waitcnt vmcnt(0)
    v_cmp_ne_u64 s[44:45], v[42:43], v[14:15]
    v_cmp_ne_u64 s[46:47], v[46:47], v[14:15]
    v_cmp_ne_u64 s[48:49], v[50:51], v[14:15]
    v_cmp_ne_u64 s[50:51], v[54:55], v[14:15]
    v_cmp_ne_u64 s[52:53], v[58:59], v[14:15]
    v_cmp_ne_u64 s[54:55], v[62:63], v[14:15]
    v_cmp_ne_u64 s[56:57], v[66:67], v[14:15]
    v_cmp_ne_u64 s[58:59], v[70:71], v[14:15]
    s_or_b64 s[10:11], s[44:45], s[46:47]
    s_or_b64 s[10:11], s[10:11], s[48:49]
    s_or_b64 s[10:11], s[10:11], s[50:51]
    s_or_b64 s[10:11], s[10:11], s[52:53]
    s_or_b64 s[10:11], s[10:11], s[54:55]
    s_or_b64 s[10:11], s[10:11], s[56:57]
    s_or_b64 s[10:11], s[10:11], s[58:59]
    s_cbranch_scc0 L_m_dp_ok0
    s_add_u32 s75, s75, 1
    s_cmp_lt_u32 s75, 240000
    s_cbranch_scc1 L_m_dp0
L_m_dp_ok0:
    v_add_f32 v40, v40, v44
    v_add_f32 v41, v41, v45
    v_add_f32 v48, v48, v52
    v_add_f32 v49, v49, v53
    v_add_f32 v56, v56, v60
    v_add_f32 v57, v57, v61
    v_add_f32 v64, v64, v68
    v_add_f32 v65, v65, v69
    v_add_f32 v40, v40, v48
    v_add_f32 v41, v41, v49
    v_add_f32 v56, v56, v64
    v_add_f32 v57, v57, v65
    v_add_f32 v40, v40, v56
    v_add_f32 v41, v41, v57
    v_mov_b32 v44, v40
    v_mov_b32 v45, v41
    s_nop 0
    v_permlane16_swap_b32 v44, v40
    v_permlane16_swap_b32 v45, v41
    v_add_f32 v40, v40, v44
    v_add_f32 v41, v41, v45
    v_mov_b32 v44, v40
    v_mov_b32 v45, v41
    s_nop 0
    v_permlane32_swap_b32 v44, v40
    v_permlane32_swap_b32 v45, v41
    v_add_f32 v40, v40, v44
    v_add_f32 v41, v41, v45
    v_cvt_pk_bf16_f32 v44, v40, v41
    v_lshlrev_b32 v40, 16, v44
    v_and_b32 v41, 0xffff0000, v44
    v_mul_f32 v40, v40, v88
    v_mul_f32 v41, v41, v88
    v_cvt_pk_bf16_f32 v44, v40, v41
    v_lshlrev_b32 v40, 16, v44
    v_and_b32 v41, 0xffff0000, v44
    s_mov_b32 s75, 0
L_lw7:
    ds_read_b32 v90, v89 offset:48
    s_waitcnt lgkmcnt(0)
    v_cmp_le_u32 vcc, 1, v90
    s_nop 3
    s_cbranch_vccnz L_lw7_ok
    s_add_u32 s75, s75, 1
    s_sleep 1
    s_cmp_lt_u32 s75, 480000
    s_cbranch_scc1 L_lw7
L_lw7_ok:
    ds_read_b64 v[44:45], v92
    s_waitcnt lgkmcnt(0)
    v_add_f32 v40, v40, v44
    v_add_f32 v41, v41, v45
    v_cvt_pk_bf16_f32 v40, v40, v41
    s_mov_b64 exec, 0xffff
    buffer_store_dword v40, v93, s[68:71], s15 offen
    s_mov_b64 exec, -1
L_m_upd_skip0:
    s_and_b32 s15, s77, 0x7ff
    s_sub_u32 s15, 2047, s15
    s_lshr_b32 s7, s15, 6
    s_cmp_eq_u32 s7, s5
    s_cbranch_scc0 L_m_upd_skip1
    s_lshl_b32 s7, s4, 16
    s_add_u32 s7, s7, 557056
    s_lshl_b32 s8, s3, 8
    s_add_u32 s7, s7, s8
    s_add_u32 s8, s7, 4096
    v_lshlrev_b32 v6, 13, v10
    v_lshl_add_u32 v6, v9, 4, v6
    s_mov_b64 s[44:45], -1
    s_mov_b64 s[46:47], -1
    s_mov_b64 s[48:49], -1
    s_mov_b64 s[50:51], -1
    s_mov_b64 s[52:53], -1
    s_mov_b64 s[54:55], -1
    s_mov_b64 s[56:57], -1
    s_mov_b64 s[58:59], -1
    s_and_b32 s9, s77, 0xffff0000
    s_ashr_i32 s10, s9, 31
    s_not_b32 s10, s10
    s_or_b32 s10, s10, 0x80000000
    s_xor_b32 s9, s9, s10
    s_and_b32 s9, s9, 0xffff0000
    v_mov_b32 v88, s9
    v_mul_f32 v88, 0xbfb8aa3b, v88
    v_exp_f32 v88, v88
    s_nop 0
    v_add_f32 v88, 1.0, v88
    v_rcp_f32 v88, v88
    s_nop 0
    v_cvt_pk_bf16_f32 v88, v88, v88
    v_and_b32 v88, 0xffff0000, v88
    s_bfe_u32 s9, s15, 0x10005
    s_lshl_b32 s9, s9, 1
    s_lshr_b32 s10, s3, 1
    s_add_u32 s9, s9, s10
    s_lshl_b32 s10, s9, 2
    v_mov_b32 v89, s10
    s_mul_i32 s9, s9, 16640
    s_and_b32 s10, s15, 31
    s_lshl_b32 s10, s10, 8
    s_add_u32 s9, s9, s10
    s_and_b32 s10, s3, 1
    s_lshl_b32 s10, s10, 7
    s_add_u32 s9, s9, s10
    s_add_u32 s9, s9, 54528
    v_lshlrev_b32 v92, 3, v9
    v_add_u32 v92, s9, v92
    s_lshl_b32 s15, s15, 11
    s_lshl_b32 s9, s4, 8
    s_add_u32 s15, s15, s9
    s_lshl_b32 s9, s3, 6
    s_add_u32 s15, s15, s9
    v_lshlrev_b32 v93, 2, v9
    s_mov_b32 s75, 0
L_m_dp1:
    s_mov_b64 exec, s[44:45]
    s_cbranch_execz L_m_dp1_s0
    buffer_load_dwordx4 v[40:43], v6, s[60:63], s7 offen sc1
L_m_dp1_s0:
    s_mov_b64 exec, s[46:47]
    s_cbranch_execz L_m_dp1_s1
    buffer_load_dwordx4 v[44:47], v6, s[60:63], s7 offen offset:1024 sc1
L_m_dp1_s1:
    s_mov_b64 exec, s[48:49]
    s_cbranch_execz L_m_dp1_s2
    buffer_load_dwordx4 v[48:51], v6, s[60:63], s7 offen offset:2048 sc1
L_m_dp1_s2:
    s_mov_b64 exec, s[50:51]
    s_cbranch_execz L_m_dp1_s3
    buffer_load_dwordx4 v[52:55], v6, s[60:63], s7 offen offset:3072 sc1
L_m_dp1_s3:
    s_mov_b64 exec, s[52:53]
    s_cbranch_execz L_m_dp1_s4
    buffer_load_dwordx4 v[56:59], v6, s[60:63], s8 offen sc1
L_m_dp1_s4:
    s_mov_b64 exec, s[54:55]
    s_cbranch_execz L_m_dp1_s5
    buffer_load_dwordx4 v[60:63], v6, s[60:63], s8 offen offset:1024 sc1
L_m_dp1_s5:
    s_mov_b64 exec, s[56:57]
    s_cbranch_execz L_m_dp1_s6
    buffer_load_dwordx4 v[64:67], v6, s[60:63], s8 offen offset:2048 sc1
L_m_dp1_s6:
    s_mov_b64 exec, s[58:59]
    s_cbranch_execz L_m_dp1_s7
    buffer_load_dwordx4 v[68:71], v6, s[60:63], s8 offen offset:3072 sc1
L_m_dp1_s7:
    s_mov_b64 exec, -1
    s_waitcnt vmcnt(0)
    v_cmp_ne_u64 s[44:45], v[42:43], v[14:15]
    v_cmp_ne_u64 s[46:47], v[46:47], v[14:15]
    v_cmp_ne_u64 s[48:49], v[50:51], v[14:15]
    v_cmp_ne_u64 s[50:51], v[54:55], v[14:15]
    v_cmp_ne_u64 s[52:53], v[58:59], v[14:15]
    v_cmp_ne_u64 s[54:55], v[62:63], v[14:15]
    v_cmp_ne_u64 s[56:57], v[66:67], v[14:15]
    v_cmp_ne_u64 s[58:59], v[70:71], v[14:15]
    s_or_b64 s[10:11], s[44:45], s[46:47]
    s_or_b64 s[10:11], s[10:11], s[48:49]
    s_or_b64 s[10:11], s[10:11], s[50:51]
    s_or_b64 s[10:11], s[10:11], s[52:53]
    s_or_b64 s[10:11], s[10:11], s[54:55]
    s_or_b64 s[10:11], s[10:11], s[56:57]
    s_or_b64 s[10:11], s[10:11], s[58:59]
    s_cbranch_scc0 L_m_dp_ok1
    s_add_u32 s75, s75, 1
    s_cmp_lt_u32 s75, 240000
    s_cbranch_scc1 L_m_dp1
L_m_dp_ok1:
    v_add_f32 v40, v40, v44
    v_add_f32 v41, v41, v45
    v_add_f32 v48, v48, v52
    v_add_f32 v49, v49, v53
    v_add_f32 v56, v56, v60
    v_add_f32 v57, v57, v61
    v_add_f32 v64, v64, v68
    v_add_f32 v65, v65, v69
    v_add_f32 v40, v40, v48
    v_add_f32 v41, v41, v49
    v_add_f32 v56, v56, v64
    v_add_f32 v57, v57, v65
    v_add_f32 v40, v40, v56
    v_add_f32 v41, v41, v57
    v_mov_b32 v44, v40
    v_mov_b32 v45, v41
    s_nop 0
    v_permlane16_swap_b32 v44, v40
    v_permlane16_swap_b32 v45, v41
    v_add_f32 v40, v40, v44
    v_add_f32 v41, v41, v45
    v_mov_b32 v44, v40
    v_mov_b32 v45, v41
    s_nop 0
    v_permlane32_swap_b32 v44, v40
    v_permlane32_swap_b32 v45, v41
    v_add_f32 v40, v40, v44
    v_add_f32 v41, v41, v45
    v_cvt_pk_bf16_f32 v44, v40, v41
    v_lshlrev_b32 v40, 16, v44
    v_and_b32 v41, 0xffff0000, v44
    v_mul_f32 v40, v40, v88
    v_mul_f32 v41, v41, v88
    v_cvt_pk_bf16_f32 v44, v40, v41
    v_lshlrev_b32 v40, 16, v44
    v_and_b32 v41, 0xffff0000, v44
    s_mov_b32 s75, 0
L_lw8:
    ds_read_b32 v90, v89 offset:48
    s_waitcnt lgkmcnt(0)
    v_cmp_le_u32 vcc, 1, v90
    s_nop 3
    s_cbranch_vccnz L_lw8_ok
    s_add_u32 s75, s75, 1
    s_sleep 1
    s_cmp_lt_u32 s75, 480000
    s_cbranch_scc1 L_lw8
L_lw8_ok:
    ds_read_b64 v[44:45], v92
    s_waitcnt lgkmcnt(0)
    v_add_f32 v40, v40, v44
    v_add_f32 v41, v41, v45
    v_cvt_pk_bf16_f32 v40, v40, v41
    s_mov_b64 exec, 0xffff
    buffer_store_dword v40, v93, s[68:71], s15 offen
    s_mov_b64 exec, -1
L_m_upd_skip1:
L_end:
    s_endpgm
L_code_end:
L_c_slow:
    s_waitcnt vmcnt(0)
    s_add_u32 s76, s42, 4194304
    s_addc_u32 s77, s43, 0
    s_and_b32 s77, s77, 0xffff
    s_mov_b32 s78, 4194304
    s_mov_b32 s79, 0x20000
    buffer_store_dwordx4 v[156:159], v3, s[76:79], 0 offen sc1
    buffer_store_dwordx4 v[160:163], v3, s[76:79], 0 offen offset:64 sc1
    buffer_store_dwordx4 v[164:167], v3, s[76:79], 0 offen offset:2048 sc1
    buffer_store_dwordx4 v[168:171], v3, s[76:79], 0 offen offset:2112 sc1
    s_waitcnt vmcnt(0)
    s_mov_b64 exec, 1
    buffer_store_dwordx2 v[54:55], v90, s[68:71], s8 offen sc1
    s_mov_b64 exec, -1
L_c_poll2:
    s_sleep 8
    buffer_load_dwordx2 v[92:93], v89, s[68:71], s7 offen sc1
    buffer_load_dwordx2 v[246:247], v89, s[68:71], s8 offen sc1
    s_waitcnt vmcnt(0)
    v_cmp_eq_u64 vcc, v[92:93], v[54:55]
    s_nop 0
    s_cmp_eq_u64 vcc, exec
    s_nop 1
    s_cbranch_scc1 L_c_fast_again
    v_cmp_eq_u64 s[12:13], v[246:247], v[54:55]
    v_and_b32 v246, -16, v246
    v_cmp_eq_u64 vcc, v[246:247], v[14:15]
    s_nop 0
    s_cmp_eq_u64 vcc, exec
    s_nop 1
    s_cbranch_scc1 L_c_slow_ok
    s_add_u32 s93, s93, 1
    s_cmp_lt_u32 s93, 60000
    s_cbranch_scc1 L_c_poll2
L_c_slow_ok:
    s_cmp_eq_u64 s[12:13], exec
    s_cselect_b32 s94, 1, 0
    buffer_load_dwordx4 v[220:223], v7, s[76:79], 0 offen sc1
    buffer_load_dwordx4 v[224:227], v7, s[76:79], s87 offen sc1
    buffer_load_dwordx4 v[228:231], v7, s[76:79], s88 offen sc1
    buffer_load_dwordx4 v[232:235], v7, s[76:79], s89 offen sc1
    s_mov_b64 exec, 1
    ds_add_u32 v1, v13 offset:16
    s_mov_b64 exec, -1
    s_waitcnt vmcnt(0)
    s_cmp_eq_u32 s94, 1
    s_cbranch_scc1 L_c_scr_out
    s_add_u32 s76, s42, 8388608
    s_addc_u32 s77, s43, 0
    s_and_b32 s77, s77, 0xffff
    s_mov_b32 s78, 4194304
    s_mov_b32 s79, 0x20000
    s_branch L_c_fetched
L_c_scr_out:
    s_mov_b32 s76, s38
    s_and_b32 s77, s39, 0xffff
    s_mov_b32 s78, 4194304
    s_mov_b32 s79, 0x20000
    s_branch L_c_fetched
L_c_fast_again:
    s_mov_b32 s76, s38
    s_and_b32 s77, s39, 0xffff
    s_mov_b32 s78, 4194304
    s_mov_b32 s79, 0x20000
    s_branch L_c_fetch
L_c_ysl:
    s_nop 7
    v_cvt_pk_bf16_f32 v16, v96, v97
    v_cvt_pk_bf16_f32 v17, v98, v99
    v_cvt_pk_bf16_f32 v18, v100, v101
    v_cvt_pk_bf16_f32 v19, v102, v103
    v_cvt_pk_bf16_f32 v20, v104, v105
    v_cvt_pk_bf16_f32 v21, v106, v107
    v_cvt_pk_bf16_f32 v22, v108, v109
    v_cvt_pk_bf16_f32 v23, v110, v111
    v_cvt_pk_bf16_f32 v24, v112, v113
    v_cvt_pk_bf16_f32 v25, v114, v115
    v_cvt_pk_bf16_f32 v26, v116, v117
    v_cvt_pk_bf16_f32 v27, v118, v119
    v_cvt_pk_bf16_f32 v28, v120, v121
    v_cvt_pk_bf16_f32 v29, v122, v123
    v_cvt_pk_bf16_f32 v30, v124, v125
    v_cvt_pk_bf16_f32 v31, v126, v127
    v_permlane16_swap_b32 v16, v18
    v_permlane16_swap_b32 v17, v19
    v_permlane16_swap_b32 v20, v22
    v_permlane16_swap_b32 v21, v23
    v_permlane16_swap_b32 v24, v26
    v_permlane16_swap_b32 v25, v27
    v_permlane16_swap_b32 v28, v30
    v_permlane16_swap_b32 v29, v31
    buffer_store_dwordx4 v[16:19], v6, s[76:79], 0 offen sc1
    buffer_store_dwordx4 v[20:23], v6, s[76:79], s87 offen sc1
    buffer_store_dwordx4 v[24:27], v6, s[76:79], s88 offen sc1
    buffer_store_dwordx4 v[28:31], v6, s[76:79], s89 offen sc1
    s_mov_b64 exec, 1
    s_waitcnt vmcnt(0)
    buffer_store_dwordx2 v[14:15], v1, s[68:71], s7 offen sc1
    s_mov_b64 exec, -1
    s_branch L_c_ydone
.section .rodata,"a"
.p2align 6
.amdhsa_kernel parallel_sum__ssm_conv_h3__moe_arch_mod__prompt_kernel
  .amdhsa_next_free_vgpr 256
  .amdhsa_next_free_sgpr 102
  .amdhsa_accum_offset 256
  .amdhsa_group_segment_fixed_size 0
  .amdhsa_kernarg_size 112
  .amdhsa_user_sgpr_count 2
  .amdhsa_user_sgpr_kernarg_segment_ptr 1
  .amdhsa_system_sgpr_workgroup_id_x 1
  .amdhsa_float_denorm_mode_32 3
.end_amdhsa_kernel
```
